```python
import torch

def _softmax(x, axis=-1):
    return torch.softmax(x, dim=axis)
def _gelu(x):
    return torch.nn.functional.gelu(x, approximate="tanh")
def _silu(x):
    return torch.nn.functional.silu(x)
def _sigmoid(x):
    return torch.sigmoid(x)
def _layernorm(x, axis=-1, eps=1e-5):
    m = x.mean(dim=axis, keepdim=True)
    v = x.var(dim=axis, keepdim=True, unbiased=False)
    return (x - m) / torch.sqrt(v + eps)
def _scatter_add(tgt, idx, src, axis=0):
    return tgt.clone().index_add_(axis, idx, src)
def _segment_sum(src, seg, n):
    out = torch.zeros((n,) + src.shape[1:], dtype=src.dtype)
    return out.index_add_(0, seg, src)
def _pad(x, pw):
    flat = tuple(v for pair in reversed(pw) for v in pair)
    return torch.nn.functional.pad(x, flat)

kernel_name = 'gated_mix__mha_block_cached__mixer_channel_mlp__decode'

def setup_inputs():

    _w = (lambda a: (lambda t: t.to(torch.bfloat16) if t.is_floating_point() else t)(torch.as_tensor(a)))
    def _A_setup():
        B, Sq, D = 8, 1, 576
        H, Sk, Dh = 32, 4096, 128
        return {
            "x": _w((lambda *s: torch.randn(*s, dtype=torch.bfloat16) * 0.05)(B, Sq, D)),
            "k_cache": _w((lambda *s: torch.randn(*s, dtype=torch.bfloat16) * 6.4)(B, H, Sk, Dh)),
            "v_cache": _w((lambda *s: torch.randn(*s, dtype=torch.bfloat16) * 0.4)(B, H, Sk, Dh)),
            "wq": _w((lambda *s: torch.randn(*s, dtype=torch.bfloat16) * 6.4)(D, H * Dh) * (D ** -0.5)),
            "wo": _w((lambda *s: torch.randn(*s, dtype=torch.bfloat16) * 0.4)(H * Dh, D) * ((H * Dh) ** -0.5)),
        }
    _A_in = _A_setup()

    def _B_setup():
        B, S, D, F = 8, 1, 576, 4608
        return {
            "x": _w((lambda *s: torch.randn(*s, dtype=torch.bfloat16) * 0.05)(B, S, D)),
            "w1": _w((lambda *s: torch.randn(*s, dtype=torch.bfloat16) * 0.8)(D, F) * (D ** -0.5)),
            "b1": _w((lambda *s: torch.randn(*s, dtype=torch.bfloat16) * 0.8)(F)),
            "w2": _w((lambda *s: torch.randn(*s, dtype=torch.bfloat16) * 0.05)(F, D) * (F ** -0.5)),
            "b2": _w((lambda *s: torch.randn(*s, dtype=torch.bfloat16) * 0.05)(D)),
        }
    _B_in = _B_setup()

    return {
        "A_x": _A_in["x"],
        "A_k_cache": _A_in["k_cache"],
        "A_v_cache": _A_in["v_cache"],
        "A_wq": _A_in["wq"],
        "A_wo": _A_in["wo"],
        "B_x": _B_in["x"],
        "B_w1": _B_in["w1"],
        "B_b1": _B_in["b1"],
        "B_w2": _B_in["w2"],
        "B_b2": _B_in["b2"],
        "gate_w": _w((lambda *s: torch.randn(*s, dtype=torch.bfloat16) * 0.05)(576) * 16.0),
    }

def reference(A_x, A_k_cache, A_v_cache, A_wq, A_wo, B_x, B_w1, B_b1, B_w2, B_b2, gate_w):
    def _A_ref(x, k_cache, v_cache, wq, wo):
        B, Sq, D = x.shape
        H, Dh = 32, 128
        q = (lambda x, *d: x.permute(*d))((x @ wq).reshape(B, Sq, H, Dh), 0, 2, 1, 3)
        scores = torch.einsum("bhqd,bhkd->bhqk", q, k_cache) * (Dh ** -0.5)
        p = _softmax(scores, axis=-1)
        o = torch.einsum("bhqk,bhkd->bhqd", p, v_cache)
        return (lambda x, *d: x.permute(*d))(o, 0, 2, 1, 3).reshape(B, Sq, H * Dh) @ wo

    def _B_ref(x, w1, b1, w2, b2):
        y = _layernorm(x, axis=-1)
        h = _gelu(torch.einsum("bsd,df->bsf", y, w1) + b1)
        return torch.einsum("bsf,fd->bsd", h, w2) + b2

    x = A_x
    g = _sigmoid((x * gate_w).sum(-1, keepdims=True))
    a = _A_ref(x, A_k_cache, A_v_cache, A_wq, A_wo)
    b = _B_ref(x, B_w1, B_b1, B_w2, B_b2)
    return g * a + (1 - g) * b
```

```asm
; @launch grid=(256,1,1) block=(512,1,1) lds=12480
.amdgcn_target "amdgcn-amd-amdhsa--gfx950"
.text
.globl gated_mix__mha_block_cached__mixer_channel_mlp__decode_kernel
.p2align 8
.type gated_mix__mha_block_cached__mixer_channel_mlp__decode_kernel,@function
gated_mix__mha_block_cached__mixer_channel_mlp__decode_kernel:
    s_cmp_ge_u32 s2, 0x100
    s_cbranch_scc1 L_end
    s_load_dwordx16 s[36:51], s[0:1], 0
    s_load_dwordx8 s[52:59], s[0:1], 64
    s_load_dwordx4 s[60:63], s[0:1], 96
    v_lshrrev_b32 v2, 6, v0
    v_and_b32 v0, 63, v0
    v_readfirstlane_b32 s3, v2
    s_lshr_b32 s64, s2, 5
    s_and_b32 s65, s2, 7
    s_lshl_b32 s65, s65, 2
    s_bfe_u32 s20, s2, 0x20003
    s_or_b32 s65, s65, s20
    s_lshl_b32 s88, s64, 5
    s_or_b32 s88, s88, s65
    s_mov_b32 s84, 0x05040100
    s_mov_b32 s85, 0x07060302
    s_mov_b32 s86, 0x3e0293ee
    s_mov_b32 s87, 0xffff0000
    s_cmp_ge_u32 s3, 4
    s_cbranch_scc1 L_helper
    s_waitcnt lgkmcnt(0)
    s_lshl_b32 s20, s88, 20
    s_add_u32 s4, s38, s20
    s_addc_u32 s5, s39, 0
    s_mov_b32 s6, 0x100000
    s_mov_b32 s7, 0x20000
    s_add_u32 s8, s40, s20
    s_addc_u32 s9, s41, 0
    s_mov_b32 s10, 0x100000
    s_mov_b32 s11, 0x20000
    v_lshlrev_b32 v1, 4, v0
    s_lshl_b32 s24, s3, 13
    s_add_u32 s25, s24, 0x1000
    s_add_u32 s26, s24, 32768
    s_add_u32 s27, s24, 36864
    s_add_u32 s28, s24, 65536
    s_add_u32 s29, s24, 69632
    buffer_load_dwordx4 v[64:67], v1, s[4:7], s24 offen offset:0 nt
    buffer_load_dwordx4 v[68:71], v1, s[4:7], s24 offen offset:1024 nt
    buffer_load_dwordx4 v[72:75], v1, s[4:7], s24 offen offset:2048 nt
    buffer_load_dwordx4 v[76:79], v1, s[4:7], s24 offen offset:3072 nt
    buffer_load_dwordx4 v[80:83], v1, s[4:7], s25 offen offset:0 nt
    s_waitcnt vmcnt(4)
    buffer_load_dwordx4 v[84:87], v1, s[4:7], s25 offen offset:1024 nt
    s_waitcnt vmcnt(4)
    buffer_load_dwordx4 v[88:91], v1, s[4:7], s25 offen offset:2048 nt
    s_waitcnt vmcnt(4)
    buffer_load_dwordx4 v[92:95], v1, s[4:7], s25 offen offset:3072 nt
    s_waitcnt vmcnt(4)
    buffer_load_dwordx4 v[96:99], v1, s[8:11], s24 offen offset:0 nt
    s_waitcnt vmcnt(4)
    buffer_load_dwordx4 v[100:103], v1, s[8:11], s24 offen offset:1024 nt
    s_waitcnt vmcnt(4)
    buffer_load_dwordx4 v[104:107], v1, s[8:11], s24 offen offset:2048 nt
    s_waitcnt vmcnt(4)
    buffer_load_dwordx4 v[108:111], v1, s[8:11], s24 offen offset:3072 nt
    s_waitcnt vmcnt(4)
    buffer_load_dwordx4 v[112:115], v1, s[8:11], s25 offen offset:0 nt
    s_waitcnt vmcnt(4)
    buffer_load_dwordx4 v[116:119], v1, s[8:11], s25 offen offset:1024 nt
    s_waitcnt vmcnt(4)
    buffer_load_dwordx4 v[120:123], v1, s[8:11], s25 offen offset:2048 nt
    s_waitcnt vmcnt(4)
    buffer_load_dwordx4 v[124:127], v1, s[8:11], s25 offen offset:3072 nt
    s_waitcnt vmcnt(4)
    buffer_load_dwordx4 v[128:131], v1, s[4:7], s26 offen offset:0 nt
    s_waitcnt vmcnt(4)
    buffer_load_dwordx4 v[132:135], v1, s[4:7], s26 offen offset:1024 nt
    s_waitcnt vmcnt(4)
    buffer_load_dwordx4 v[136:139], v1, s[4:7], s26 offen offset:2048 nt
    s_waitcnt vmcnt(4)
    buffer_load_dwordx4 v[140:143], v1, s[4:7], s26 offen offset:3072 nt
    s_waitcnt vmcnt(4)
    buffer_load_dwordx4 v[144:147], v1, s[4:7], s27 offen offset:0 nt
    s_waitcnt vmcnt(4)
    buffer_load_dwordx4 v[148:151], v1, s[4:7], s27 offen offset:1024 nt
    s_waitcnt vmcnt(4)
    buffer_load_dwordx4 v[152:155], v1, s[4:7], s27 offen offset:2048 nt
    s_waitcnt vmcnt(4)
    buffer_load_dwordx4 v[156:159], v1, s[4:7], s27 offen offset:3072 nt
    s_waitcnt vmcnt(4)
    buffer_load_dwordx4 v[160:163], v1, s[8:11], s26 offen offset:0 nt
    s_waitcnt vmcnt(4)
    buffer_load_dwordx4 v[164:167], v1, s[8:11], s26 offen offset:1024 nt
    s_waitcnt vmcnt(4)
    buffer_load_dwordx4 v[168:171], v1, s[8:11], s26 offen offset:2048 nt
    s_waitcnt vmcnt(4)
    buffer_load_dwordx4 v[172:175], v1, s[8:11], s26 offen offset:3072 nt
    s_waitcnt vmcnt(4)
    buffer_load_dwordx4 v[176:179], v1, s[8:11], s27 offen offset:0 nt
    s_waitcnt vmcnt(4)
    buffer_load_dwordx4 v[180:183], v1, s[8:11], s27 offen offset:1024 nt
    s_waitcnt vmcnt(4)
    buffer_load_dwordx4 v[184:187], v1, s[8:11], s27 offen offset:2048 nt
    s_waitcnt vmcnt(4)
    buffer_load_dwordx4 v[188:191], v1, s[8:11], s27 offen offset:3072 nt
    s_waitcnt vmcnt(4)
    buffer_load_dwordx4 v[192:195], v1, s[4:7], s28 offen offset:0 nt
    s_waitcnt vmcnt(4)
    buffer_load_dwordx4 v[196:199], v1, s[4:7], s28 offen offset:1024 nt
    s_waitcnt vmcnt(4)
    buffer_load_dwordx4 v[200:203], v1, s[4:7], s28 offen offset:2048 nt
    s_waitcnt vmcnt(4)
    buffer_load_dwordx4 v[204:207], v1, s[4:7], s28 offen offset:3072 nt
    s_waitcnt vmcnt(4)
    buffer_load_dwordx4 v[208:211], v1, s[4:7], s29 offen offset:0 nt
    s_waitcnt vmcnt(4)
    buffer_load_dwordx4 v[212:215], v1, s[4:7], s29 offen offset:1024 nt
    s_waitcnt vmcnt(4)
    buffer_load_dwordx4 v[216:219], v1, s[4:7], s29 offen offset:2048 nt
    s_waitcnt vmcnt(4)
    buffer_load_dwordx4 v[220:223], v1, s[4:7], s29 offen offset:3072 nt
    s_waitcnt vmcnt(4)
    buffer_load_dwordx4 v[224:227], v1, s[8:11], s28 offen offset:0 nt
    s_waitcnt vmcnt(4)
    buffer_load_dwordx4 v[228:231], v1, s[8:11], s28 offen offset:1024 nt
    s_waitcnt vmcnt(4)
    buffer_load_dwordx4 v[232:235], v1, s[8:11], s28 offen offset:2048 nt
    s_waitcnt vmcnt(4)
    buffer_load_dwordx4 v[236:239], v1, s[8:11], s28 offen offset:3072 nt
    s_waitcnt vmcnt(4)
    buffer_load_dwordx4 v[240:243], v1, s[8:11], s29 offen offset:0 nt
    s_waitcnt vmcnt(4)
    buffer_load_dwordx4 v[244:247], v1, s[8:11], s29 offen offset:1024 nt
    s_waitcnt vmcnt(4)
    buffer_load_dwordx4 v[248:251], v1, s[8:11], s29 offen offset:2048 nt
    s_waitcnt vmcnt(4)
    buffer_load_dwordx4 v[252:255], v1, s[8:11], s29 offen offset:3072 nt
    s_add_u32 s24, s24, 98304
    s_add_u32 s25, s25, 98304
    s_add_u32 s26, s26, 98304
    s_add_u32 s27, s27, 98304
    s_add_u32 s28, s28, 98304
    s_add_u32 s29, s29, 98304
    v_mov_b32 v14, 0
    v_mov_b32 v15, 0
    v_mov_b32 v16, 0
    v_mov_b32 v17, 0
    v_mov_b32 v18, 0
    v_mov_b32 v19, 0
    v_mov_b32 v20, 0
    v_mov_b32 v21, 0
    v_mov_b32 v23, 0
    v_mov_b32 v22, 0xff7fffff
    v_and_b32 v25, 15, v0
    v_lshlrev_b32 v25, 5, v25
    v_lshrrev_b32 v24, 4, v0
    v_lshl_add_u32 v42, v24, 3, v25
    s_lshl_b32 s20, s3, 9
    v_add_u32 v42, s20, v42
    s_lshl_b32 s20, s3, 3
    v_mov_b32 v43, s20
    s_barrier
    ds_read_b128 v[26:29], v25 offset:0
    ds_read_b128 v[30:33], v25 offset:16
    ds_read_b128 v[34:37], v25 offset:512
    ds_read_b128 v[38:41], v25 offset:528
    s_waitcnt lgkmcnt(0)
    v_add_f32 v6, v26, v34
    v_add_f32 v7, v27, v35
    v_add_f32 v8, v28, v36
    v_add_f32 v9, v29, v37
    v_add_f32 v10, v30, v38
    v_add_f32 v11, v31, v39
    v_add_f32 v12, v32, v40
    v_add_f32 v13, v33, v41
    ds_read_b128 v[26:29], v25 offset:1024
    ds_read_b128 v[30:33], v25 offset:1040
    ds_read_b128 v[34:37], v25 offset:1536
    ds_read_b128 v[38:41], v25 offset:1552
    s_waitcnt lgkmcnt(0)
    v_add_f32 v26, v26, v34
    v_add_f32 v6, v6, v26
    v_add_f32 v27, v27, v35
    v_add_f32 v7, v7, v27
    v_add_f32 v28, v28, v36
    v_add_f32 v8, v8, v28
    v_add_f32 v29, v29, v37
    v_add_f32 v9, v9, v29
    v_add_f32 v30, v30, v38
    v_add_f32 v10, v10, v30
    v_add_f32 v31, v31, v39
    v_add_f32 v11, v11, v31
    v_add_f32 v32, v32, v40
    v_add_f32 v12, v12, v32
    v_add_f32 v33, v33, v41
    v_add_f32 v13, v13, v33
    v_cvt_pk_bf16_f32 v2, v6, v7
    v_cvt_pk_bf16_f32 v3, v8, v9
    v_cvt_pk_bf16_f32 v4, v10, v11
    v_cvt_pk_bf16_f32 v5, v12, v13
    s_mov_b32 s23, 9
    s_nop 2
.p2align 6
L_sloop:
    v_dot2_f32_bf16 v6, v64, v2, 0
    v_dot2_f32_bf16 v7, v68, v2, 0
    v_dot2_f32_bf16 v6, v65, v3, v6
    v_dot2_f32_bf16 v7, v69, v3, v7
    v_dot2_f32_bf16 v6, v66, v4, v6
    v_dot2_f32_bf16 v7, v70, v4, v7
    v_dot2_f32_bf16 v6, v67, v5, v6
    v_dot2_f32_bf16 v7, v71, v5, v7
    s_waitcnt vmcnt(4)
    buffer_load_dwordx4 v[64:67], v1, s[4:7], s24 offen offset:0 nt
    v_dot2_f32_bf16 v8, v72, v2, 0
    v_dot2_f32_bf16 v9, v76, v2, 0
    v_dot2_f32_bf16 v8, v73, v3, v8
    v_dot2_f32_bf16 v9, v77, v3, v9
    v_dot2_f32_bf16 v8, v74, v4, v8
    v_dot2_f32_bf16 v9, v78, v4, v9
    v_dot2_f32_bf16 v8, v75, v5, v8
    v_dot2_f32_bf16 v9, v79, v5, v9
    v_dot2_f32_bf16 v10, v80, v2, 0
    v_dot2_f32_bf16 v11, v84, v2, 0
    v_dot2_f32_bf16 v10, v81, v3, v10
    s_waitcnt vmcnt(4)
    buffer_load_dwordx4 v[68:71], v1, s[4:7], s24 offen offset:1024 nt
    v_dot2_f32_bf16 v11, v85, v3, v11
    v_dot2_f32_bf16 v10, v82, v4, v10
    v_dot2_f32_bf16 v11, v86, v4, v11
    v_dot2_f32_bf16 v10, v83, v5, v10
    v_dot2_f32_bf16 v11, v87, v5, v11
    v_dot2_f32_bf16 v12, v88, v2, 0
    v_dot2_f32_bf16 v13, v92, v2, 0
    v_dot2_f32_bf16 v12, v89, v3, v12
    v_dot2_f32_bf16 v13, v93, v3, v13
    v_dot2_f32_bf16 v12, v90, v4, v12
    v_dot2_f32_bf16 v13, v94, v4, v13
    v_dot2_f32_bf16 v12, v91, v5, v12
    s_waitcnt vmcnt(4)
    buffer_load_dwordx4 v[72:75], v1, s[4:7], s24 offen offset:2048 nt
    v_dot2_f32_bf16 v13, v95, v5, v13
    v_add_f32_dpp v6, v6, v6 row_ror:8 row_mask:0xf bank_mask:0xf
    v_add_f32_dpp v7, v7, v7 row_ror:8 row_mask:0xf bank_mask:0xf
    v_add_f32_dpp v8, v8, v8 row_ror:8 row_mask:0xf bank_mask:0xf
    v_add_f32_dpp v9, v9, v9 row_ror:8 row_mask:0xf bank_mask:0xf
    v_add_f32_dpp v10, v10, v10 row_ror:8 row_mask:0xf bank_mask:0xf
    v_add_f32_dpp v11, v11, v11 row_ror:8 row_mask:0xf bank_mask:0xf
    v_add_f32_dpp v12, v12, v12 row_ror:8 row_mask:0xf bank_mask:0xf
    v_add_f32_dpp v13, v13, v13 row_ror:8 row_mask:0xf bank_mask:0xf
    v_add_f32_dpp v6, v6, v6 row_ror:4 row_mask:0xf bank_mask:0xf
    v_add_f32_dpp v7, v7, v7 row_ror:4 row_mask:0xf bank_mask:0xf
    v_add_f32_dpp v8, v8, v8 row_ror:4 row_mask:0xf bank_mask:0xf
    v_add_f32_dpp v9, v9, v9 row_ror:4 row_mask:0xf bank_mask:0xf
    s_waitcnt vmcnt(4)
    buffer_load_dwordx4 v[76:79], v1, s[4:7], s24 offen offset:3072 nt
    v_add_f32_dpp v10, v10, v10 row_ror:4 row_mask:0xf bank_mask:0xf
    v_add_f32_dpp v11, v11, v11 row_ror:4 row_mask:0xf bank_mask:0xf
    v_add_f32_dpp v12, v12, v12 row_ror:4 row_mask:0xf bank_mask:0xf
    v_add_f32_dpp v13, v13, v13 row_ror:4 row_mask:0xf bank_mask:0xf
    v_add_f32_dpp v6, v6, v6 row_ror:2 row_mask:0xf bank_mask:0xf
    v_add_f32_dpp v7, v7, v7 row_ror:2 row_mask:0xf bank_mask:0xf
    v_add_f32_dpp v8, v8, v8 row_ror:2 row_mask:0xf bank_mask:0xf
    v_add_f32_dpp v9, v9, v9 row_ror:2 row_mask:0xf bank_mask:0xf
    v_add_f32_dpp v10, v10, v10 row_ror:2 row_mask:0xf bank_mask:0xf
    v_add_f32_dpp v11, v11, v11 row_ror:2 row_mask:0xf bank_mask:0xf
    v_add_f32_dpp v12, v12, v12 row_ror:2 row_mask:0xf bank_mask:0xf
    v_add_f32_dpp v13, v13, v13 row_ror:2 row_mask:0xf bank_mask:0xf
    s_waitcnt vmcnt(4)
    buffer_load_dwordx4 v[80:83], v1, s[4:7], s25 offen offset:0 nt
    v_add_f32_dpp v6, v6, v6 row_ror:1 row_mask:0xf bank_mask:0xf
    v_add_f32_dpp v7, v7, v7 row_ror:1 row_mask:0xf bank_mask:0xf
    v_add_f32_dpp v8, v8, v8 row_ror:1 row_mask:0xf bank_mask:0xf
    v_add_f32_dpp v9, v9, v9 row_ror:1 row_mask:0xf bank_mask:0xf
    v_add_f32_dpp v10, v10, v10 row_ror:1 row_mask:0xf bank_mask:0xf
    v_add_f32_dpp v11, v11, v11 row_ror:1 row_mask:0xf bank_mask:0xf
    v_add_f32_dpp v12, v12, v12 row_ror:1 row_mask:0xf bank_mask:0xf
    v_add_f32_dpp v13, v13, v13 row_ror:1 row_mask:0xf bank_mask:0xf
    v_max3_f32 v25, v6, v7, v8
    v_max3_f32 v24, v9, v10, v11
    v_max3_f32 v25, v25, v12, v13
    v_max_f32 v25, v25, v24
    s_waitcnt vmcnt(4)
    buffer_load_dwordx4 v[84:87], v1, s[4:7], s25 offen offset:1024 nt
    v_mul_f32 v25, s86, v25
    v_max_f32 v25, v25, v22
    v_sub_f32 v24, v22, v25
    v_mov_b32 v22, v25
    v_exp_f32 v24, v24
    v_fma_f32 v6, v6, s86, -v22
    v_fma_f32 v7, v7, s86, -v22
    v_fma_f32 v8, v8, s86, -v22
    v_fma_f32 v9, v9, s86, -v22
    v_fma_f32 v10, v10, s86, -v22
    v_fma_f32 v11, v11, s86, -v22
    v_fma_f32 v12, v12, s86, -v22
    v_fma_f32 v13, v13, s86, -v22
    s_waitcnt vmcnt(4)
    buffer_load_dwordx4 v[88:91], v1, s[4:7], s25 offen offset:2048 nt
    v_exp_f32 v6, v6
    v_exp_f32 v7, v7
    v_exp_f32 v8, v8
    v_exp_f32 v9, v9
    v_exp_f32 v10, v10
    v_exp_f32 v11, v11
    v_exp_f32 v12, v12
    v_exp_f32 v13, v13
    v_pk_mul_f32 v[14:15], v[14:15], v[24:25] op_sel:[0,0] op_sel_hi:[1,0]
    v_pk_mul_f32 v[16:17], v[16:17], v[24:25] op_sel:[0,0] op_sel_hi:[1,0]
    v_pk_mul_f32 v[18:19], v[18:19], v[24:25] op_sel:[0,0] op_sel_hi:[1,0]
    v_pk_mul_f32 v[20:21], v[20:21], v[24:25] op_sel:[0,0] op_sel_hi:[1,0]
    s_waitcnt vmcnt(4)
    buffer_load_dwordx4 v[92:95], v1, s[4:7], s25 offen offset:3072 nt
    v_fma_f32 v23, v23, v24, v6
    v_add_f32 v25, v7, v8
    v_add_f32 v26, v9, v10
    v_add_f32 v23, v23, v11
    v_add_f32 v25, v25, v12
    v_add_f32 v26, v26, v13
    v_add_f32 v23, v23, v25
    v_add_f32 v23, v23, v26
    v_lshlrev_b32 v26, 16, v96
    v_and_b32 v27, s87, v96
    v_pk_fma_f32 v[14:15], v[26:27], v[6:7], v[14:15] op_sel:[0,0,0] op_sel_hi:[1,0,1]
    v_lshlrev_b32 v28, 16, v97
    v_and_b32 v29, s87, v97
    v_pk_fma_f32 v[16:17], v[28:29], v[6:7], v[16:17] op_sel:[0,0,0] op_sel_hi:[1,0,1]
    v_lshlrev_b32 v30, 16, v98
    v_and_b32 v31, s87, v98
    v_pk_fma_f32 v[18:19], v[30:31], v[6:7], v[18:19] op_sel:[0,0,0] op_sel_hi:[1,0,1]
    v_lshlrev_b32 v32, 16, v99
    v_and_b32 v33, s87, v99
    v_pk_fma_f32 v[20:21], v[32:33], v[6:7], v[20:21] op_sel:[0,0,0] op_sel_hi:[1,0,1]
    s_waitcnt vmcnt(4)
    buffer_load_dwordx4 v[96:99], v1, s[8:11], s24 offen offset:0 nt
    v_lshlrev_b32 v26, 16, v100
    v_and_b32 v27, s87, v100
    v_pk_fma_f32 v[14:15], v[26:27], v[6:7], v[14:15] op_sel:[0,1,0] op_sel_hi:[1,1,1]
    v_lshlrev_b32 v28, 16, v101
    v_and_b32 v29, s87, v101
    v_pk_fma_f32 v[16:17], v[28:29], v[6:7], v[16:17] op_sel:[0,1,0] op_sel_hi:[1,1,1]
    v_lshlrev_b32 v30, 16, v102
    v_and_b32 v31, s87, v102
    v_pk_fma_f32 v[18:19], v[30:31], v[6:7], v[18:19] op_sel:[0,1,0] op_sel_hi:[1,1,1]
    v_lshlrev_b32 v32, 16, v103
    v_and_b32 v33, s87, v103
    v_pk_fma_f32 v[20:21], v[32:33], v[6:7], v[20:21] op_sel:[0,1,0] op_sel_hi:[1,1,1]
    s_waitcnt vmcnt(4)
    buffer_load_dwordx4 v[100:103], v1, s[8:11], s24 offen offset:1024 nt
    v_lshlrev_b32 v26, 16, v104
    v_and_b32 v27, s87, v104
    v_pk_fma_f32 v[14:15], v[26:27], v[8:9], v[14:15] op_sel:[0,0,0] op_sel_hi:[1,0,1]
    v_lshlrev_b32 v28, 16, v105
    v_and_b32 v29, s87, v105
    v_pk_fma_f32 v[16:17], v[28:29], v[8:9], v[16:17] op_sel:[0,0,0] op_sel_hi:[1,0,1]
    v_lshlrev_b32 v30, 16, v106
    v_and_b32 v31, s87, v106
    v_pk_fma_f32 v[18:19], v[30:31], v[8:9], v[18:19] op_sel:[0,0,0] op_sel_hi:[1,0,1]
    v_lshlrev_b32 v32, 16, v107
    v_and_b32 v33, s87, v107
    v_pk_fma_f32 v[20:21], v[32:33], v[8:9], v[20:21] op_sel:[0,0,0] op_sel_hi:[1,0,1]
    s_waitcnt vmcnt(4)
    buffer_load_dwordx4 v[104:107], v1, s[8:11], s24 offen offset:2048 nt
    v_lshlrev_b32 v26, 16, v108
    v_and_b32 v27, s87, v108
    v_pk_fma_f32 v[14:15], v[26:27], v[8:9], v[14:15] op_sel:[0,1,0] op_sel_hi:[1,1,1]
    v_lshlrev_b32 v28, 16, v109
    v_and_b32 v29, s87, v109
    v_pk_fma_f32 v[16:17], v[28:29], v[8:9], v[16:17] op_sel:[0,1,0] op_sel_hi:[1,1,1]
    v_lshlrev_b32 v30, 16, v110
    v_and_b32 v31, s87, v110
    v_pk_fma_f32 v[18:19], v[30:31], v[8:9], v[18:19] op_sel:[0,1,0] op_sel_hi:[1,1,1]
    v_lshlrev_b32 v32, 16, v111
    v_and_b32 v33, s87, v111
    v_pk_fma_f32 v[20:21], v[32:33], v[8:9], v[20:21] op_sel:[0,1,0] op_sel_hi:[1,1,1]
    s_waitcnt vmcnt(4)
    buffer_load_dwordx4 v[108:111], v1, s[8:11], s24 offen offset:3072 nt
    v_lshlrev_b32 v26, 16, v112
    v_and_b32 v27, s87, v112
    v_pk_fma_f32 v[14:15], v[26:27], v[10:11], v[14:15] op_sel:[0,0,0] op_sel_hi:[1,0,1]
    v_lshlrev_b32 v28, 16, v113
    v_and_b32 v29, s87, v113
    v_pk_fma_f32 v[16:17], v[28:29], v[10:11], v[16:17] op_sel:[0,0,0] op_sel_hi:[1,0,1]
    v_lshlrev_b32 v30, 16, v114
    v_and_b32 v31, s87, v114
    v_pk_fma_f32 v[18:19], v[30:31], v[10:11], v[18:19] op_sel:[0,0,0] op_sel_hi:[1,0,1]
    v_lshlrev_b32 v32, 16, v115
    v_and_b32 v33, s87, v115
    v_pk_fma_f32 v[20:21], v[32:33], v[10:11], v[20:21] op_sel:[0,0,0] op_sel_hi:[1,0,1]
    s_waitcnt vmcnt(4)
    buffer_load_dwordx4 v[112:115], v1, s[8:11], s25 offen offset:0 nt
    v_lshlrev_b32 v26, 16, v116
    v_and_b32 v27, s87, v116
    v_pk_fma_f32 v[14:15], v[26:27], v[10:11], v[14:15] op_sel:[0,1,0] op_sel_hi:[1,1,1]
    v_lshlrev_b32 v28, 16, v117
    v_and_b32 v29, s87, v117
    v_pk_fma_f32 v[16:17], v[28:29], v[10:11], v[16:17] op_sel:[0,1,0] op_sel_hi:[1,1,1]
    v_lshlrev_b32 v30, 16, v118
    v_and_b32 v31, s87, v118
    v_pk_fma_f32 v[18:19], v[30:31], v[10:11], v[18:19] op_sel:[0,1,0] op_sel_hi:[1,1,1]
    v_lshlrev_b32 v32, 16, v119
    v_and_b32 v33, s87, v119
    v_pk_fma_f32 v[20:21], v[32:33], v[10:11], v[20:21] op_sel:[0,1,0] op_sel_hi:[1,1,1]
    s_waitcnt vmcnt(4)
    buffer_load_dwordx4 v[116:119], v1, s[8:11], s25 offen offset:1024 nt
    v_lshlrev_b32 v26, 16, v120
    v_and_b32 v27, s87, v120
    v_pk_fma_f32 v[14:15], v[26:27], v[12:13], v[14:15] op_sel:[0,0,0] op_sel_hi:[1,0,1]
    v_lshlrev_b32 v28, 16, v121
    v_and_b32 v29, s87, v121
    v_pk_fma_f32 v[16:17], v[28:29], v[12:13], v[16:17] op_sel:[0,0,0] op_sel_hi:[1,0,1]
    v_lshlrev_b32 v30, 16, v122
    v_and_b32 v31, s87, v122
    v_pk_fma_f32 v[18:19], v[30:31], v[12:13], v[18:19] op_sel:[0,0,0] op_sel_hi:[1,0,1]
    v_lshlrev_b32 v32, 16, v123
    v_and_b32 v33, s87, v123
    v_pk_fma_f32 v[20:21], v[32:33], v[12:13], v[20:21] op_sel:[0,0,0] op_sel_hi:[1,0,1]
    s_waitcnt vmcnt(4)
    buffer_load_dwordx4 v[120:123], v1, s[8:11], s25 offen offset:2048 nt
    v_lshlrev_b32 v26, 16, v124
    v_and_b32 v27, s87, v124
    v_pk_fma_f32 v[14:15], v[26:27], v[12:13], v[14:15] op_sel:[0,1,0] op_sel_hi:[1,1,1]
    v_lshlrev_b32 v28, 16, v125
    v_and_b32 v29, s87, v125
    v_pk_fma_f32 v[16:17], v[28:29], v[12:13], v[16:17] op_sel:[0,1,0] op_sel_hi:[1,1,1]
    v_lshlrev_b32 v30, 16, v126
    v_and_b32 v31, s87, v126
    v_pk_fma_f32 v[18:19], v[30:31], v[12:13], v[18:19] op_sel:[0,1,0] op_sel_hi:[1,1,1]
    v_lshlrev_b32 v32, 16, v127
    v_and_b32 v33, s87, v127
    v_pk_fma_f32 v[20:21], v[32:33], v[12:13], v[20:21] op_sel:[0,1,0] op_sel_hi:[1,1,1]
    s_waitcnt vmcnt(4)
    buffer_load_dwordx4 v[124:127], v1, s[8:11], s25 offen offset:3072 nt
    v_dot2_f32_bf16 v6, v128, v2, 0
    v_dot2_f32_bf16 v7, v132, v2, 0
    v_dot2_f32_bf16 v6, v129, v3, v6
    v_dot2_f32_bf16 v7, v133, v3, v7
    v_dot2_f32_bf16 v6, v130, v4, v6
    v_dot2_f32_bf16 v7, v134, v4, v7
    v_dot2_f32_bf16 v6, v131, v5, v6
    v_dot2_f32_bf16 v7, v135, v5, v7
    s_waitcnt vmcnt(4)
    buffer_load_dwordx4 v[128:131], v1, s[4:7], s26 offen offset:0 nt
    v_dot2_f32_bf16 v8, v136, v2, 0
    v_dot2_f32_bf16 v9, v140, v2, 0
    v_dot2_f32_bf16 v8, v137, v3, v8
    v_dot2_f32_bf16 v9, v141, v3, v9
    v_dot2_f32_bf16 v8, v138, v4, v8
    v_dot2_f32_bf16 v9, v142, v4, v9
    v_dot2_f32_bf16 v8, v139, v5, v8
    v_dot2_f32_bf16 v9, v143, v5, v9
    v_dot2_f32_bf16 v10, v144, v2, 0
    v_dot2_f32_bf16 v11, v148, v2, 0
    v_dot2_f32_bf16 v10, v145, v3, v10
    s_waitcnt vmcnt(4)
    buffer_load_dwordx4 v[132:135], v1, s[4:7], s26 offen offset:1024 nt
    v_dot2_f32_bf16 v11, v149, v3, v11
    v_dot2_f32_bf16 v10, v146, v4, v10
    v_dot2_f32_bf16 v11, v150, v4, v11
    v_dot2_f32_bf16 v10, v147, v5, v10
    v_dot2_f32_bf16 v11, v151, v5, v11
    v_dot2_f32_bf16 v12, v152, v2, 0
    v_dot2_f32_bf16 v13, v156, v2, 0
    v_dot2_f32_bf16 v12, v153, v3, v12
    v_dot2_f32_bf16 v13, v157, v3, v13
    v_dot2_f32_bf16 v12, v154, v4, v12
    v_dot2_f32_bf16 v13, v158, v4, v13
    v_dot2_f32_bf16 v12, v155, v5, v12
    s_waitcnt vmcnt(4)
    buffer_load_dwordx4 v[136:139], v1, s[4:7], s26 offen offset:2048 nt
    v_dot2_f32_bf16 v13, v159, v5, v13
    v_add_f32_dpp v6, v6, v6 row_ror:8 row_mask:0xf bank_mask:0xf
    v_add_f32_dpp v7, v7, v7 row_ror:8 row_mask:0xf bank_mask:0xf
    v_add_f32_dpp v8, v8, v8 row_ror:8 row_mask:0xf bank_mask:0xf
    v_add_f32_dpp v9, v9, v9 row_ror:8 row_mask:0xf bank_mask:0xf
    v_add_f32_dpp v10, v10, v10 row_ror:8 row_mask:0xf bank_mask:0xf
    v_add_f32_dpp v11, v11, v11 row_ror:8 row_mask:0xf bank_mask:0xf
    v_add_f32_dpp v12, v12, v12 row_ror:8 row_mask:0xf bank_mask:0xf
    v_add_f32_dpp v13, v13, v13 row_ror:8 row_mask:0xf bank_mask:0xf
    v_add_f32_dpp v6, v6, v6 row_ror:4 row_mask:0xf bank_mask:0xf
    v_add_f32_dpp v7, v7, v7 row_ror:4 row_mask:0xf bank_mask:0xf
    v_add_f32_dpp v8, v8, v8 row_ror:4 row_mask:0xf bank_mask:0xf
    v_add_f32_dpp v9, v9, v9 row_ror:4 row_mask:0xf bank_mask:0xf
    s_waitcnt vmcnt(4)
    buffer_load_dwordx4 v[140:143], v1, s[4:7], s26 offen offset:3072 nt
    v_add_f32_dpp v10, v10, v10 row_ror:4 row_mask:0xf bank_mask:0xf
    v_add_f32_dpp v11, v11, v11 row_ror:4 row_mask:0xf bank_mask:0xf
    v_add_f32_dpp v12, v12, v12 row_ror:4 row_mask:0xf bank_mask:0xf
    v_add_f32_dpp v13, v13, v13 row_ror:4 row_mask:0xf bank_mask:0xf
    v_add_f32_dpp v6, v6, v6 row_ror:2 row_mask:0xf bank_mask:0xf
    v_add_f32_dpp v7, v7, v7 row_ror:2 row_mask:0xf bank_mask:0xf
    v_add_f32_dpp v8, v8, v8 row_ror:2 row_mask:0xf bank_mask:0xf
    v_add_f32_dpp v9, v9, v9 row_ror:2 row_mask:0xf bank_mask:0xf
    v_add_f32_dpp v10, v10, v10 row_ror:2 row_mask:0xf bank_mask:0xf
    v_add_f32_dpp v11, v11, v11 row_ror:2 row_mask:0xf bank_mask:0xf
    v_add_f32_dpp v12, v12, v12 row_ror:2 row_mask:0xf bank_mask:0xf
    v_add_f32_dpp v13, v13, v13 row_ror:2 row_mask:0xf bank_mask:0xf
    s_waitcnt vmcnt(4)
    buffer_load_dwordx4 v[144:147], v1, s[4:7], s27 offen offset:0 nt
    v_add_f32_dpp v6, v6, v6 row_ror:1 row_mask:0xf bank_mask:0xf
    v_add_f32_dpp v7, v7, v7 row_ror:1 row_mask:0xf bank_mask:0xf
    v_add_f32_dpp v8, v8, v8 row_ror:1 row_mask:0xf bank_mask:0xf
    v_add_f32_dpp v9, v9, v9 row_ror:1 row_mask:0xf bank_mask:0xf
    v_add_f32_dpp v10, v10, v10 row_ror:1 row_mask:0xf bank_mask:0xf
    v_add_f32_dpp v11, v11, v11 row_ror:1 row_mask:0xf bank_mask:0xf
    v_add_f32_dpp v12, v12, v12 row_ror:1 row_mask:0xf bank_mask:0xf
    v_add_f32_dpp v13, v13, v13 row_ror:1 row_mask:0xf bank_mask:0xf
    v_max3_f32 v25, v6, v7, v8
    v_max3_f32 v24, v9, v10, v11
    v_max3_f32 v25, v25, v12, v13
    v_max_f32 v25, v25, v24
    s_waitcnt vmcnt(4)
    buffer_load_dwordx4 v[148:151], v1, s[4:7], s27 offen offset:1024 nt
    v_mul_f32 v25, s86, v25
    v_max_f32 v25, v25, v22
    v_sub_f32 v24, v22, v25
    v_mov_b32 v22, v25
    v_exp_f32 v24, v24
    v_fma_f32 v6, v6, s86, -v22
    v_fma_f32 v7, v7, s86, -v22
    v_fma_f32 v8, v8, s86, -v22
    v_fma_f32 v9, v9, s86, -v22
    v_fma_f32 v10, v10, s86, -v22
    v_fma_f32 v11, v11, s86, -v22
    v_fma_f32 v12, v12, s86, -v22
    v_fma_f32 v13, v13, s86, -v22
    s_waitcnt vmcnt(4)
    buffer_load_dwordx4 v[152:155], v1, s[4:7], s27 offen offset:2048 nt
    v_exp_f32 v6, v6
    v_exp_f32 v7, v7
    v_exp_f32 v8, v8
    v_exp_f32 v9, v9
    v_exp_f32 v10, v10
    v_exp_f32 v11, v11
    v_exp_f32 v12, v12
    v_exp_f32 v13, v13
    v_pk_mul_f32 v[14:15], v[14:15], v[24:25] op_sel:[0,0] op_sel_hi:[1,0]
    v_pk_mul_f32 v[16:17], v[16:17], v[24:25] op_sel:[0,0] op_sel_hi:[1,0]
    v_pk_mul_f32 v[18:19], v[18:19], v[24:25] op_sel:[0,0] op_sel_hi:[1,0]
    v_pk_mul_f32 v[20:21], v[20:21], v[24:25] op_sel:[0,0] op_sel_hi:[1,0]
    s_waitcnt vmcnt(4)
    buffer_load_dwordx4 v[156:159], v1, s[4:7], s27 offen offset:3072 nt
    v_fma_f32 v23, v23, v24, v6
    v_add_f32 v25, v7, v8
    v_add_f32 v26, v9, v10
    v_add_f32 v23, v23, v11
    v_add_f32 v25, v25, v12
    v_add_f32 v26, v26, v13
    v_add_f32 v23, v23, v25
    v_add_f32 v23, v23, v26
    v_lshlrev_b32 v26, 16, v160
    v_and_b32 v27, s87, v160
    v_pk_fma_f32 v[14:15], v[26:27], v[6:7], v[14:15] op_sel:[0,0,0] op_sel_hi:[1,0,1]
    v_lshlrev_b32 v28, 16, v161
    v_and_b32 v29, s87, v161
    v_pk_fma_f32 v[16:17], v[28:29], v[6:7], v[16:17] op_sel:[0,0,0] op_sel_hi:[1,0,1]
    v_lshlrev_b32 v30, 16, v162
    v_and_b32 v31, s87, v162
    v_pk_fma_f32 v[18:19], v[30:31], v[6:7], v[18:19] op_sel:[0,0,0] op_sel_hi:[1,0,1]
    v_lshlrev_b32 v32, 16, v163
    v_and_b32 v33, s87, v163
    v_pk_fma_f32 v[20:21], v[32:33], v[6:7], v[20:21] op_sel:[0,0,0] op_sel_hi:[1,0,1]
    s_waitcnt vmcnt(4)
    buffer_load_dwordx4 v[160:163], v1, s[8:11], s26 offen offset:0 nt
    v_lshlrev_b32 v26, 16, v164
    v_and_b32 v27, s87, v164
    v_pk_fma_f32 v[14:15], v[26:27], v[6:7], v[14:15] op_sel:[0,1,0] op_sel_hi:[1,1,1]
    v_lshlrev_b32 v28, 16, v165
    v_and_b32 v29, s87, v165
    v_pk_fma_f32 v[16:17], v[28:29], v[6:7], v[16:17] op_sel:[0,1,0] op_sel_hi:[1,1,1]
    v_lshlrev_b32 v30, 16, v166
    v_and_b32 v31, s87, v166
    v_pk_fma_f32 v[18:19], v[30:31], v[6:7], v[18:19] op_sel:[0,1,0] op_sel_hi:[1,1,1]
    v_lshlrev_b32 v32, 16, v167
    v_and_b32 v33, s87, v167
    v_pk_fma_f32 v[20:21], v[32:33], v[6:7], v[20:21] op_sel:[0,1,0] op_sel_hi:[1,1,1]
    s_waitcnt vmcnt(4)
    buffer_load_dwordx4 v[164:167], v1, s[8:11], s26 offen offset:1024 nt
    v_lshlrev_b32 v26, 16, v168
    v_and_b32 v27, s87, v168
    v_pk_fma_f32 v[14:15], v[26:27], v[8:9], v[14:15] op_sel:[0,0,0] op_sel_hi:[1,0,1]
    v_lshlrev_b32 v28, 16, v169
    v_and_b32 v29, s87, v169
    v_pk_fma_f32 v[16:17], v[28:29], v[8:9], v[16:17] op_sel:[0,0,0] op_sel_hi:[1,0,1]
    v_lshlrev_b32 v30, 16, v170
    v_and_b32 v31, s87, v170
    v_pk_fma_f32 v[18:19], v[30:31], v[8:9], v[18:19] op_sel:[0,0,0] op_sel_hi:[1,0,1]
    v_lshlrev_b32 v32, 16, v171
    v_and_b32 v33, s87, v171
    v_pk_fma_f32 v[20:21], v[32:33], v[8:9], v[20:21] op_sel:[0,0,0] op_sel_hi:[1,0,1]
    s_waitcnt vmcnt(4)
    buffer_load_dwordx4 v[168:171], v1, s[8:11], s26 offen offset:2048 nt
    v_lshlrev_b32 v26, 16, v172
    v_and_b32 v27, s87, v172
    v_pk_fma_f32 v[14:15], v[26:27], v[8:9], v[14:15] op_sel:[0,1,0] op_sel_hi:[1,1,1]
    v_lshlrev_b32 v28, 16, v173
    v_and_b32 v29, s87, v173
    v_pk_fma_f32 v[16:17], v[28:29], v[8:9], v[16:17] op_sel:[0,1,0] op_sel_hi:[1,1,1]
    v_lshlrev_b32 v30, 16, v174
    v_and_b32 v31, s87, v174
    v_pk_fma_f32 v[18:19], v[30:31], v[8:9], v[18:19] op_sel:[0,1,0] op_sel_hi:[1,1,1]
    v_lshlrev_b32 v32, 16, v175
    v_and_b32 v33, s87, v175
    v_pk_fma_f32 v[20:21], v[32:33], v[8:9], v[20:21] op_sel:[0,1,0] op_sel_hi:[1,1,1]
    s_waitcnt vmcnt(4)
    buffer_load_dwordx4 v[172:175], v1, s[8:11], s26 offen offset:3072 nt
    v_lshlrev_b32 v26, 16, v176
    v_and_b32 v27, s87, v176
    v_pk_fma_f32 v[14:15], v[26:27], v[10:11], v[14:15] op_sel:[0,0,0] op_sel_hi:[1,0,1]
    v_lshlrev_b32 v28, 16, v177
    v_and_b32 v29, s87, v177
    v_pk_fma_f32 v[16:17], v[28:29], v[10:11], v[16:17] op_sel:[0,0,0] op_sel_hi:[1,0,1]
    v_lshlrev_b32 v30, 16, v178
    v_and_b32 v31, s87, v178
    v_pk_fma_f32 v[18:19], v[30:31], v[10:11], v[18:19] op_sel:[0,0,0] op_sel_hi:[1,0,1]
    v_lshlrev_b32 v32, 16, v179
    v_and_b32 v33, s87, v179
    v_pk_fma_f32 v[20:21], v[32:33], v[10:11], v[20:21] op_sel:[0,0,0] op_sel_hi:[1,0,1]
    s_waitcnt vmcnt(4)
    buffer_load_dwordx4 v[176:179], v1, s[8:11], s27 offen offset:0 nt
    v_lshlrev_b32 v26, 16, v180
    v_and_b32 v27, s87, v180
    v_pk_fma_f32 v[14:15], v[26:27], v[10:11], v[14:15] op_sel:[0,1,0] op_sel_hi:[1,1,1]
    v_lshlrev_b32 v28, 16, v181
    v_and_b32 v29, s87, v181
    v_pk_fma_f32 v[16:17], v[28:29], v[10:11], v[16:17] op_sel:[0,1,0] op_sel_hi:[1,1,1]
    v_lshlrev_b32 v30, 16, v182
    v_and_b32 v31, s87, v182
    v_pk_fma_f32 v[18:19], v[30:31], v[10:11], v[18:19] op_sel:[0,1,0] op_sel_hi:[1,1,1]
    v_lshlrev_b32 v32, 16, v183
    v_and_b32 v33, s87, v183
    v_pk_fma_f32 v[20:21], v[32:33], v[10:11], v[20:21] op_sel:[0,1,0] op_sel_hi:[1,1,1]
    s_waitcnt vmcnt(4)
    buffer_load_dwordx4 v[180:183], v1, s[8:11], s27 offen offset:1024 nt
    v_lshlrev_b32 v26, 16, v184
    v_and_b32 v27, s87, v184
    v_pk_fma_f32 v[14:15], v[26:27], v[12:13], v[14:15] op_sel:[0,0,0] op_sel_hi:[1,0,1]
    v_lshlrev_b32 v28, 16, v185
    v_and_b32 v29, s87, v185
    v_pk_fma_f32 v[16:17], v[28:29], v[12:13], v[16:17] op_sel:[0,0,0] op_sel_hi:[1,0,1]
    v_lshlrev_b32 v30, 16, v186
    v_and_b32 v31, s87, v186
    v_pk_fma_f32 v[18:19], v[30:31], v[12:13], v[18:19] op_sel:[0,0,0] op_sel_hi:[1,0,1]
    v_lshlrev_b32 v32, 16, v187
    v_and_b32 v33, s87, v187
    v_pk_fma_f32 v[20:21], v[32:33], v[12:13], v[20:21] op_sel:[0,0,0] op_sel_hi:[1,0,1]
    s_waitcnt vmcnt(4)
    buffer_load_dwordx4 v[184:187], v1, s[8:11], s27 offen offset:2048 nt
    v_lshlrev_b32 v26, 16, v188
    v_and_b32 v27, s87, v188
    v_pk_fma_f32 v[14:15], v[26:27], v[12:13], v[14:15] op_sel:[0,1,0] op_sel_hi:[1,1,1]
    v_lshlrev_b32 v28, 16, v189
    v_and_b32 v29, s87, v189
    v_pk_fma_f32 v[16:17], v[28:29], v[12:13], v[16:17] op_sel:[0,1,0] op_sel_hi:[1,1,1]
    v_lshlrev_b32 v30, 16, v190
    v_and_b32 v31, s87, v190
    v_pk_fma_f32 v[18:19], v[30:31], v[12:13], v[18:19] op_sel:[0,1,0] op_sel_hi:[1,1,1]
    v_lshlrev_b32 v32, 16, v191
    v_and_b32 v33, s87, v191
    v_pk_fma_f32 v[20:21], v[32:33], v[12:13], v[20:21] op_sel:[0,1,0] op_sel_hi:[1,1,1]
    s_waitcnt vmcnt(4)
    buffer_load_dwordx4 v[188:191], v1, s[8:11], s27 offen offset:3072 nt
    v_dot2_f32_bf16 v6, v192, v2, 0
    v_dot2_f32_bf16 v7, v196, v2, 0
    v_dot2_f32_bf16 v6, v193, v3, v6
    v_dot2_f32_bf16 v7, v197, v3, v7
    v_dot2_f32_bf16 v6, v194, v4, v6
    v_dot2_f32_bf16 v7, v198, v4, v7
    v_dot2_f32_bf16 v6, v195, v5, v6
    v_dot2_f32_bf16 v7, v199, v5, v7
    s_waitcnt vmcnt(4)
    buffer_load_dwordx4 v[192:195], v1, s[4:7], s28 offen offset:0 nt
    v_dot2_f32_bf16 v8, v200, v2, 0
    v_dot2_f32_bf16 v9, v204, v2, 0
    v_dot2_f32_bf16 v8, v201, v3, v8
    v_dot2_f32_bf16 v9, v205, v3, v9
    v_dot2_f32_bf16 v8, v202, v4, v8
    v_dot2_f32_bf16 v9, v206, v4, v9
    v_dot2_f32_bf16 v8, v203, v5, v8
    v_dot2_f32_bf16 v9, v207, v5, v9
    v_dot2_f32_bf16 v10, v208, v2, 0
    v_dot2_f32_bf16 v11, v212, v2, 0
    v_dot2_f32_bf16 v10, v209, v3, v10
    s_waitcnt vmcnt(4)
    buffer_load_dwordx4 v[196:199], v1, s[4:7], s28 offen offset:1024 nt
    v_dot2_f32_bf16 v11, v213, v3, v11
    v_dot2_f32_bf16 v10, v210, v4, v10
    v_dot2_f32_bf16 v11, v214, v4, v11
    v_dot2_f32_bf16 v10, v211, v5, v10
    v_dot2_f32_bf16 v11, v215, v5, v11
    v_dot2_f32_bf16 v12, v216, v2, 0
    v_dot2_f32_bf16 v13, v220, v2, 0
    v_dot2_f32_bf16 v12, v217, v3, v12
    v_dot2_f32_bf16 v13, v221, v3, v13
    v_dot2_f32_bf16 v12, v218, v4, v12
    v_dot2_f32_bf16 v13, v222, v4, v13
    v_dot2_f32_bf16 v12, v219, v5, v12
    s_waitcnt vmcnt(4)
    buffer_load_dwordx4 v[200:203], v1, s[4:7], s28 offen offset:2048 nt
    v_dot2_f32_bf16 v13, v223, v5, v13
    v_add_f32_dpp v6, v6, v6 row_ror:8 row_mask:0xf bank_mask:0xf
    v_add_f32_dpp v7, v7, v7 row_ror:8 row_mask:0xf bank_mask:0xf
    v_add_f32_dpp v8, v8, v8 row_ror:8 row_mask:0xf bank_mask:0xf
    v_add_f32_dpp v9, v9, v9 row_ror:8 row_mask:0xf bank_mask:0xf
    v_add_f32_dpp v10, v10, v10 row_ror:8 row_mask:0xf bank_mask:0xf
    v_add_f32_dpp v11, v11, v11 row_ror:8 row_mask:0xf bank_mask:0xf
    v_add_f32_dpp v12, v12, v12 row_ror:8 row_mask:0xf bank_mask:0xf
    v_add_f32_dpp v13, v13, v13 row_ror:8 row_mask:0xf bank_mask:0xf
    v_add_f32_dpp v6, v6, v6 row_ror:4 row_mask:0xf bank_mask:0xf
    v_add_f32_dpp v7, v7, v7 row_ror:4 row_mask:0xf bank_mask:0xf
    v_add_f32_dpp v8, v8, v8 row_ror:4 row_mask:0xf bank_mask:0xf
    v_add_f32_dpp v9, v9, v9 row_ror:4 row_mask:0xf bank_mask:0xf
    s_waitcnt vmcnt(4)
    buffer_load_dwordx4 v[204:207], v1, s[4:7], s28 offen offset:3072 nt
    v_add_f32_dpp v10, v10, v10 row_ror:4 row_mask:0xf bank_mask:0xf
    v_add_f32_dpp v11, v11, v11 row_ror:4 row_mask:0xf bank_mask:0xf
    v_add_f32_dpp v12, v12, v12 row_ror:4 row_mask:0xf bank_mask:0xf
    v_add_f32_dpp v13, v13, v13 row_ror:4 row_mask:0xf bank_mask:0xf
    v_add_f32_dpp v6, v6, v6 row_ror:2 row_mask:0xf bank_mask:0xf
    v_add_f32_dpp v7, v7, v7 row_ror:2 row_mask:0xf bank_mask:0xf
    v_add_f32_dpp v8, v8, v8 row_ror:2 row_mask:0xf bank_mask:0xf
    v_add_f32_dpp v9, v9, v9 row_ror:2 row_mask:0xf bank_mask:0xf
    v_add_f32_dpp v10, v10, v10 row_ror:2 row_mask:0xf bank_mask:0xf
    v_add_f32_dpp v11, v11, v11 row_ror:2 row_mask:0xf bank_mask:0xf
    v_add_f32_dpp v12, v12, v12 row_ror:2 row_mask:0xf bank_mask:0xf
    v_add_f32_dpp v13, v13, v13 row_ror:2 row_mask:0xf bank_mask:0xf
    s_waitcnt vmcnt(4)
    buffer_load_dwordx4 v[208:211], v1, s[4:7], s29 offen offset:0 nt
    v_add_f32_dpp v6, v6, v6 row_ror:1 row_mask:0xf bank_mask:0xf
    v_add_f32_dpp v7, v7, v7 row_ror:1 row_mask:0xf bank_mask:0xf
    v_add_f32_dpp v8, v8, v8 row_ror:1 row_mask:0xf bank_mask:0xf
    v_add_f32_dpp v9, v9, v9 row_ror:1 row_mask:0xf bank_mask:0xf
    v_add_f32_dpp v10, v10, v10 row_ror:1 row_mask:0xf bank_mask:0xf
    v_add_f32_dpp v11, v11, v11 row_ror:1 row_mask:0xf bank_mask:0xf
    v_add_f32_dpp v12, v12, v12 row_ror:1 row_mask:0xf bank_mask:0xf
    v_add_f32_dpp v13, v13, v13 row_ror:1 row_mask:0xf bank_mask:0xf
    v_max3_f32 v25, v6, v7, v8
    v_max3_f32 v24, v9, v10, v11
    v_max3_f32 v25, v25, v12, v13
    v_max_f32 v25, v25, v24
    s_waitcnt vmcnt(4)
    buffer_load_dwordx4 v[212:215], v1, s[4:7], s29 offen offset:1024 nt
    v_mul_f32 v25, s86, v25
    v_max_f32 v25, v25, v22
    v_sub_f32 v24, v22, v25
    v_mov_b32 v22, v25
    v_exp_f32 v24, v24
    v_fma_f32 v6, v6, s86, -v22
    v_fma_f32 v7, v7, s86, -v22
    v_fma_f32 v8, v8, s86, -v22
    v_fma_f32 v9, v9, s86, -v22
    v_fma_f32 v10, v10, s86, -v22
    v_fma_f32 v11, v11, s86, -v22
    v_fma_f32 v12, v12, s86, -v22
    v_fma_f32 v13, v13, s86, -v22
    s_waitcnt vmcnt(4)
    buffer_load_dwordx4 v[216:219], v1, s[4:7], s29 offen offset:2048 nt
    v_exp_f32 v6, v6
    v_exp_f32 v7, v7
    v_exp_f32 v8, v8
    v_exp_f32 v9, v9
    v_exp_f32 v10, v10
    v_exp_f32 v11, v11
    v_exp_f32 v12, v12
    v_exp_f32 v13, v13
    v_pk_mul_f32 v[14:15], v[14:15], v[24:25] op_sel:[0,0] op_sel_hi:[1,0]
    v_pk_mul_f32 v[16:17], v[16:17], v[24:25] op_sel:[0,0] op_sel_hi:[1,0]
    v_pk_mul_f32 v[18:19], v[18:19], v[24:25] op_sel:[0,0] op_sel_hi:[1,0]
    v_pk_mul_f32 v[20:21], v[20:21], v[24:25] op_sel:[0,0] op_sel_hi:[1,0]
    s_waitcnt vmcnt(4)
    buffer_load_dwordx4 v[220:223], v1, s[4:7], s29 offen offset:3072 nt
    v_fma_f32 v23, v23, v24, v6
    v_add_f32 v25, v7, v8
    v_add_f32 v26, v9, v10
    v_add_f32 v23, v23, v11
    v_add_f32 v25, v25, v12
    v_add_f32 v26, v26, v13
    v_add_f32 v23, v23, v25
    v_add_f32 v23, v23, v26
    v_lshlrev_b32 v26, 16, v224
    v_and_b32 v27, s87, v224
    v_pk_fma_f32 v[14:15], v[26:27], v[6:7], v[14:15] op_sel:[0,0,0] op_sel_hi:[1,0,1]
    v_lshlrev_b32 v28, 16, v225
    v_and_b32 v29, s87, v225
    v_pk_fma_f32 v[16:17], v[28:29], v[6:7], v[16:17] op_sel:[0,0,0] op_sel_hi:[1,0,1]
    v_lshlrev_b32 v30, 16, v226
    v_and_b32 v31, s87, v226
    v_pk_fma_f32 v[18:19], v[30:31], v[6:7], v[18:19] op_sel:[0,0,0] op_sel_hi:[1,0,1]
    v_lshlrev_b32 v32, 16, v227
    v_and_b32 v33, s87, v227
    v_pk_fma_f32 v[20:21], v[32:33], v[6:7], v[20:21] op_sel:[0,0,0] op_sel_hi:[1,0,1]
    s_waitcnt vmcnt(4)
    buffer_load_dwordx4 v[224:227], v1, s[8:11], s28 offen offset:0 nt
    v_lshlrev_b32 v26, 16, v228
    v_and_b32 v27, s87, v228
    v_pk_fma_f32 v[14:15], v[26:27], v[6:7], v[14:15] op_sel:[0,1,0] op_sel_hi:[1,1,1]
    v_lshlrev_b32 v28, 16, v229
    v_and_b32 v29, s87, v229
    v_pk_fma_f32 v[16:17], v[28:29], v[6:7], v[16:17] op_sel:[0,1,0] op_sel_hi:[1,1,1]
    v_lshlrev_b32 v30, 16, v230
    v_and_b32 v31, s87, v230
    v_pk_fma_f32 v[18:19], v[30:31], v[6:7], v[18:19] op_sel:[0,1,0] op_sel_hi:[1,1,1]
    v_lshlrev_b32 v32, 16, v231
    v_and_b32 v33, s87, v231
    v_pk_fma_f32 v[20:21], v[32:33], v[6:7], v[20:21] op_sel:[0,1,0] op_sel_hi:[1,1,1]
    s_waitcnt vmcnt(4)
    buffer_load_dwordx4 v[228:231], v1, s[8:11], s28 offen offset:1024 nt
    v_lshlrev_b32 v26, 16, v232
    v_and_b32 v27, s87, v232
    v_pk_fma_f32 v[14:15], v[26:27], v[8:9], v[14:15] op_sel:[0,0,0] op_sel_hi:[1,0,1]
    v_lshlrev_b32 v28, 16, v233
    v_and_b32 v29, s87, v233
    v_pk_fma_f32 v[16:17], v[28:29], v[8:9], v[16:17] op_sel:[0,0,0] op_sel_hi:[1,0,1]
    v_lshlrev_b32 v30, 16, v234
    v_and_b32 v31, s87, v234
    v_pk_fma_f32 v[18:19], v[30:31], v[8:9], v[18:19] op_sel:[0,0,0] op_sel_hi:[1,0,1]
    v_lshlrev_b32 v32, 16, v235
    v_and_b32 v33, s87, v235
    v_pk_fma_f32 v[20:21], v[32:33], v[8:9], v[20:21] op_sel:[0,0,0] op_sel_hi:[1,0,1]
    s_waitcnt vmcnt(4)
    buffer_load_dwordx4 v[232:235], v1, s[8:11], s28 offen offset:2048 nt
    v_lshlrev_b32 v26, 16, v236
    v_and_b32 v27, s87, v236
    v_pk_fma_f32 v[14:15], v[26:27], v[8:9], v[14:15] op_sel:[0,1,0] op_sel_hi:[1,1,1]
    v_lshlrev_b32 v28, 16, v237
    v_and_b32 v29, s87, v237
    v_pk_fma_f32 v[16:17], v[28:29], v[8:9], v[16:17] op_sel:[0,1,0] op_sel_hi:[1,1,1]
    v_lshlrev_b32 v30, 16, v238
    v_and_b32 v31, s87, v238
    v_pk_fma_f32 v[18:19], v[30:31], v[8:9], v[18:19] op_sel:[0,1,0] op_sel_hi:[1,1,1]
    v_lshlrev_b32 v32, 16, v239
    v_and_b32 v33, s87, v239
    v_pk_fma_f32 v[20:21], v[32:33], v[8:9], v[20:21] op_sel:[0,1,0] op_sel_hi:[1,1,1]
    s_waitcnt vmcnt(4)
    buffer_load_dwordx4 v[236:239], v1, s[8:11], s28 offen offset:3072 nt
    v_lshlrev_b32 v26, 16, v240
    v_and_b32 v27, s87, v240
    v_pk_fma_f32 v[14:15], v[26:27], v[10:11], v[14:15] op_sel:[0,0,0] op_sel_hi:[1,0,1]
    v_lshlrev_b32 v28, 16, v241
    v_and_b32 v29, s87, v241
    v_pk_fma_f32 v[16:17], v[28:29], v[10:11], v[16:17] op_sel:[0,0,0] op_sel_hi:[1,0,1]
    v_lshlrev_b32 v30, 16, v242
    v_and_b32 v31, s87, v242
    v_pk_fma_f32 v[18:19], v[30:31], v[10:11], v[18:19] op_sel:[0,0,0] op_sel_hi:[1,0,1]
    v_lshlrev_b32 v32, 16, v243
    v_and_b32 v33, s87, v243
    v_pk_fma_f32 v[20:21], v[32:33], v[10:11], v[20:21] op_sel:[0,0,0] op_sel_hi:[1,0,1]
    s_waitcnt vmcnt(4)
    buffer_load_dwordx4 v[240:243], v1, s[8:11], s29 offen offset:0 nt
    v_lshlrev_b32 v26, 16, v244
    v_and_b32 v27, s87, v244
    v_pk_fma_f32 v[14:15], v[26:27], v[10:11], v[14:15] op_sel:[0,1,0] op_sel_hi:[1,1,1]
    v_lshlrev_b32 v28, 16, v245
    v_and_b32 v29, s87, v245
    v_pk_fma_f32 v[16:17], v[28:29], v[10:11], v[16:17] op_sel:[0,1,0] op_sel_hi:[1,1,1]
    v_lshlrev_b32 v30, 16, v246
    v_and_b32 v31, s87, v246
    v_pk_fma_f32 v[18:19], v[30:31], v[10:11], v[18:19] op_sel:[0,1,0] op_sel_hi:[1,1,1]
    v_lshlrev_b32 v32, 16, v247
    v_and_b32 v33, s87, v247
    v_pk_fma_f32 v[20:21], v[32:33], v[10:11], v[20:21] op_sel:[0,1,0] op_sel_hi:[1,1,1]
    s_waitcnt vmcnt(4)
    buffer_load_dwordx4 v[244:247], v1, s[8:11], s29 offen offset:1024 nt
    v_lshlrev_b32 v26, 16, v248
    v_and_b32 v27, s87, v248
    v_pk_fma_f32 v[14:15], v[26:27], v[12:13], v[14:15] op_sel:[0,0,0] op_sel_hi:[1,0,1]
    v_lshlrev_b32 v28, 16, v249
    v_and_b32 v29, s87, v249
    v_pk_fma_f32 v[16:17], v[28:29], v[12:13], v[16:17] op_sel:[0,0,0] op_sel_hi:[1,0,1]
    v_lshlrev_b32 v30, 16, v250
    v_and_b32 v31, s87, v250
    v_pk_fma_f32 v[18:19], v[30:31], v[12:13], v[18:19] op_sel:[0,0,0] op_sel_hi:[1,0,1]
    v_lshlrev_b32 v32, 16, v251
    v_and_b32 v33, s87, v251
    v_pk_fma_f32 v[20:21], v[32:33], v[12:13], v[20:21] op_sel:[0,0,0] op_sel_hi:[1,0,1]
    s_waitcnt vmcnt(4)
    buffer_load_dwordx4 v[248:251], v1, s[8:11], s29 offen offset:2048 nt
    v_lshlrev_b32 v26, 16, v252
    v_and_b32 v27, s87, v252
    v_pk_fma_f32 v[14:15], v[26:27], v[12:13], v[14:15] op_sel:[0,1,0] op_sel_hi:[1,1,1]
    v_lshlrev_b32 v28, 16, v253
    v_and_b32 v29, s87, v253
    v_pk_fma_f32 v[16:17], v[28:29], v[12:13], v[16:17] op_sel:[0,1,0] op_sel_hi:[1,1,1]
    v_lshlrev_b32 v30, 16, v254
    v_and_b32 v31, s87, v254
    v_pk_fma_f32 v[18:19], v[30:31], v[12:13], v[18:19] op_sel:[0,1,0] op_sel_hi:[1,1,1]
    v_lshlrev_b32 v32, 16, v255
    v_and_b32 v33, s87, v255
    v_pk_fma_f32 v[20:21], v[32:33], v[12:13], v[20:21] op_sel:[0,1,0] op_sel_hi:[1,1,1]
    s_waitcnt vmcnt(4)
    buffer_load_dwordx4 v[252:255], v1, s[8:11], s29 offen offset:3072 nt
    s_add_u32 s24, s24, 98304
    s_add_u32 s25, s25, 98304
    s_add_u32 s26, s26, 98304
    s_add_u32 s27, s27, 98304
    s_add_u32 s28, s28, 98304
    s_add_u32 s29, s29, 98304
    s_sub_u32 s23, s23, 1
    s_cmp_lg_u32 s23, 0
    s_nop 2
    s_cbranch_scc1 L_sloop
    v_dot2_f32_bf16 v6, v64, v2, 0
    v_dot2_f32_bf16 v7, v68, v2, 0
    v_dot2_f32_bf16 v6, v65, v3, v6
    v_dot2_f32_bf16 v7, v69, v3, v7
    v_dot2_f32_bf16 v6, v66, v4, v6
    v_dot2_f32_bf16 v7, v70, v4, v7
    v_dot2_f32_bf16 v6, v67, v5, v6
    v_dot2_f32_bf16 v7, v71, v5, v7
    v_dot2_f32_bf16 v8, v72, v2, 0
    v_dot2_f32_bf16 v9, v76, v2, 0
    v_dot2_f32_bf16 v8, v73, v3, v8
    v_dot2_f32_bf16 v9, v77, v3, v9
    v_dot2_f32_bf16 v8, v74, v4, v8
    v_dot2_f32_bf16 v9, v78, v4, v9
    v_dot2_f32_bf16 v8, v75, v5, v8
    v_dot2_f32_bf16 v9, v79, v5, v9
    s_waitcnt vmcnt(9)
    buffer_load_dwordx4 v[64:67], v1, s[4:7], s24 offen offset:0 nt
    v_dot2_f32_bf16 v10, v80, v2, 0
    v_dot2_f32_bf16 v11, v84, v2, 0
    v_dot2_f32_bf16 v10, v81, v3, v10
    v_dot2_f32_bf16 v11, v85, v3, v11
    v_dot2_f32_bf16 v10, v82, v4, v10
    v_dot2_f32_bf16 v11, v86, v4, v11
    v_dot2_f32_bf16 v10, v83, v5, v10
    v_dot2_f32_bf16 v11, v87, v5, v11
    s_waitcnt vmcnt(9)
    buffer_load_dwordx4 v[68:71], v1, s[4:7], s24 offen offset:1024 nt
    v_dot2_f32_bf16 v12, v88, v2, 0
    v_dot2_f32_bf16 v13, v92, v2, 0
    v_dot2_f32_bf16 v12, v89, v3, v12
    v_dot2_f32_bf16 v13, v93, v3, v13
    v_dot2_f32_bf16 v12, v90, v4, v12
    v_dot2_f32_bf16 v13, v94, v4, v13
    v_dot2_f32_bf16 v12, v91, v5, v12
    v_dot2_f32_bf16 v13, v95, v5, v13
    s_waitcnt vmcnt(9)
    buffer_load_dwordx4 v[72:75], v1, s[4:7], s24 offen offset:2048 nt
    v_add_f32_dpp v6, v6, v6 row_ror:8 row_mask:0xf bank_mask:0xf
    v_add_f32_dpp v7, v7, v7 row_ror:8 row_mask:0xf bank_mask:0xf
    v_add_f32_dpp v8, v8, v8 row_ror:8 row_mask:0xf bank_mask:0xf
    v_add_f32_dpp v9, v9, v9 row_ror:8 row_mask:0xf bank_mask:0xf
    v_add_f32_dpp v10, v10, v10 row_ror:8 row_mask:0xf bank_mask:0xf
    v_add_f32_dpp v11, v11, v11 row_ror:8 row_mask:0xf bank_mask:0xf
    v_add_f32_dpp v12, v12, v12 row_ror:8 row_mask:0xf bank_mask:0xf
    v_add_f32_dpp v13, v13, v13 row_ror:8 row_mask:0xf bank_mask:0xf
    v_add_f32_dpp v6, v6, v6 row_ror:4 row_mask:0xf bank_mask:0xf
    v_add_f32_dpp v7, v7, v7 row_ror:4 row_mask:0xf bank_mask:0xf
    v_add_f32_dpp v8, v8, v8 row_ror:4 row_mask:0xf bank_mask:0xf
    v_add_f32_dpp v9, v9, v9 row_ror:4 row_mask:0xf bank_mask:0xf
    v_add_f32_dpp v10, v10, v10 row_ror:4 row_mask:0xf bank_mask:0xf
    v_add_f32_dpp v11, v11, v11 row_ror:4 row_mask:0xf bank_mask:0xf
    v_add_f32_dpp v12, v12, v12 row_ror:4 row_mask:0xf bank_mask:0xf
    v_add_f32_dpp v13, v13, v13 row_ror:4 row_mask:0xf bank_mask:0xf
    v_add_f32_dpp v6, v6, v6 row_ror:2 row_mask:0xf bank_mask:0xf
    v_add_f32_dpp v7, v7, v7 row_ror:2 row_mask:0xf bank_mask:0xf
    v_add_f32_dpp v8, v8, v8 row_ror:2 row_mask:0xf bank_mask:0xf
    v_add_f32_dpp v9, v9, v9 row_ror:2 row_mask:0xf bank_mask:0xf
    v_add_f32_dpp v10, v10, v10 row_ror:2 row_mask:0xf bank_mask:0xf
    v_add_f32_dpp v11, v11, v11 row_ror:2 row_mask:0xf bank_mask:0xf
    v_add_f32_dpp v12, v12, v12 row_ror:2 row_mask:0xf bank_mask:0xf
    v_add_f32_dpp v13, v13, v13 row_ror:2 row_mask:0xf bank_mask:0xf
    v_add_f32_dpp v6, v6, v6 row_ror:1 row_mask:0xf bank_mask:0xf
    v_add_f32_dpp v7, v7, v7 row_ror:1 row_mask:0xf bank_mask:0xf
    v_add_f32_dpp v8, v8, v8 row_ror:1 row_mask:0xf bank_mask:0xf
    v_add_f32_dpp v9, v9, v9 row_ror:1 row_mask:0xf bank_mask:0xf
    v_add_f32_dpp v10, v10, v10 row_ror:1 row_mask:0xf bank_mask:0xf
    v_add_f32_dpp v11, v11, v11 row_ror:1 row_mask:0xf bank_mask:0xf
    v_add_f32_dpp v12, v12, v12 row_ror:1 row_mask:0xf bank_mask:0xf
    v_add_f32_dpp v13, v13, v13 row_ror:1 row_mask:0xf bank_mask:0xf
    v_max3_f32 v25, v6, v7, v8
    v_max3_f32 v24, v9, v10, v11
    v_max3_f32 v25, v25, v12, v13
    v_max_f32 v25, v25, v24
    v_mul_f32 v25, s86, v25
    v_max_f32 v25, v25, v22
    v_sub_f32 v24, v22, v25
    v_mov_b32 v22, v25
    v_exp_f32 v24, v24
    v_fma_f32 v6, v6, s86, -v22
    v_fma_f32 v7, v7, s86, -v22
    v_fma_f32 v8, v8, s86, -v22
    v_fma_f32 v9, v9, s86, -v22
    v_fma_f32 v10, v10, s86, -v22
    v_fma_f32 v11, v11, s86, -v22
    v_fma_f32 v12, v12, s86, -v22
    v_fma_f32 v13, v13, s86, -v22
    v_exp_f32 v6, v6
    v_exp_f32 v7, v7
    v_exp_f32 v8, v8
    v_exp_f32 v9, v9
    v_exp_f32 v10, v10
    v_exp_f32 v11, v11
    v_exp_f32 v12, v12
    v_exp_f32 v13, v13
    v_pk_mul_f32 v[14:15], v[14:15], v[24:25] op_sel:[0,0] op_sel_hi:[1,0]
    v_pk_mul_f32 v[16:17], v[16:17], v[24:25] op_sel:[0,0] op_sel_hi:[1,0]
    v_pk_mul_f32 v[18:19], v[18:19], v[24:25] op_sel:[0,0] op_sel_hi:[1,0]
    v_pk_mul_f32 v[20:21], v[20:21], v[24:25] op_sel:[0,0] op_sel_hi:[1,0]
    v_fma_f32 v23, v23, v24, v6
    v_add_f32 v25, v7, v8
    v_add_f32 v26, v9, v10
    v_add_f32 v23, v23, v11
    v_add_f32 v25, v25, v12
    v_add_f32 v26, v26, v13
    v_add_f32 v23, v23, v25
    v_add_f32 v23, v23, v26
    v_lshlrev_b32 v26, 16, v96
    v_and_b32 v27, s87, v96
    v_pk_fma_f32 v[14:15], v[26:27], v[6:7], v[14:15] op_sel:[0,0,0] op_sel_hi:[1,0,1]
    v_lshlrev_b32 v28, 16, v97
    v_and_b32 v29, s87, v97
    v_pk_fma_f32 v[16:17], v[28:29], v[6:7], v[16:17] op_sel:[0,0,0] op_sel_hi:[1,0,1]
    v_lshlrev_b32 v30, 16, v98
    v_and_b32 v31, s87, v98
    v_pk_fma_f32 v[18:19], v[30:31], v[6:7], v[18:19] op_sel:[0,0,0] op_sel_hi:[1,0,1]
    v_lshlrev_b32 v32, 16, v99
    v_and_b32 v33, s87, v99
    v_pk_fma_f32 v[20:21], v[32:33], v[6:7], v[20:21] op_sel:[0,0,0] op_sel_hi:[1,0,1]
    s_waitcnt vmcnt(9)
    buffer_load_dwordx4 v[76:79], v1, s[4:7], s24 offen offset:3072 nt
    v_lshlrev_b32 v26, 16, v100
    v_and_b32 v27, s87, v100
    v_pk_fma_f32 v[14:15], v[26:27], v[6:7], v[14:15] op_sel:[0,1,0] op_sel_hi:[1,1,1]
    v_lshlrev_b32 v28, 16, v101
    v_and_b32 v29, s87, v101
    v_pk_fma_f32 v[16:17], v[28:29], v[6:7], v[16:17] op_sel:[0,1,0] op_sel_hi:[1,1,1]
    v_lshlrev_b32 v30, 16, v102
    v_and_b32 v31, s87, v102
    v_pk_fma_f32 v[18:19], v[30:31], v[6:7], v[18:19] op_sel:[0,1,0] op_sel_hi:[1,1,1]
    v_lshlrev_b32 v32, 16, v103
    v_and_b32 v33, s87, v103
    v_pk_fma_f32 v[20:21], v[32:33], v[6:7], v[20:21] op_sel:[0,1,0] op_sel_hi:[1,1,1]
    v_lshlrev_b32 v26, 16, v104
    v_and_b32 v27, s87, v104
    v_pk_fma_f32 v[14:15], v[26:27], v[8:9], v[14:15] op_sel:[0,0,0] op_sel_hi:[1,0,1]
    v_lshlrev_b32 v28, 16, v105
    v_and_b32 v29, s87, v105
    v_pk_fma_f32 v[16:17], v[28:29], v[8:9], v[16:17] op_sel:[0,0,0] op_sel_hi:[1,0,1]
    v_lshlrev_b32 v30, 16, v106
    v_and_b32 v31, s87, v106
    v_pk_fma_f32 v[18:19], v[30:31], v[8:9], v[18:19] op_sel:[0,0,0] op_sel_hi:[1,0,1]
    v_lshlrev_b32 v32, 16, v107
    v_and_b32 v33, s87, v107
    v_pk_fma_f32 v[20:21], v[32:33], v[8:9], v[20:21] op_sel:[0,0,0] op_sel_hi:[1,0,1]
    s_waitcnt vmcnt(9)
    buffer_load_dwordx4 v[80:83], v1, s[4:7], s25 offen offset:0 nt
    v_lshlrev_b32 v26, 16, v108
    v_and_b32 v27, s87, v108
    v_pk_fma_f32 v[14:15], v[26:27], v[8:9], v[14:15] op_sel:[0,1,0] op_sel_hi:[1,1,1]
    v_lshlrev_b32 v28, 16, v109
    v_and_b32 v29, s87, v109
    v_pk_fma_f32 v[16:17], v[28:29], v[8:9], v[16:17] op_sel:[0,1,0] op_sel_hi:[1,1,1]
    v_lshlrev_b32 v30, 16, v110
    v_and_b32 v31, s87, v110
    v_pk_fma_f32 v[18:19], v[30:31], v[8:9], v[18:19] op_sel:[0,1,0] op_sel_hi:[1,1,1]
    v_lshlrev_b32 v32, 16, v111
    v_and_b32 v33, s87, v111
    v_pk_fma_f32 v[20:21], v[32:33], v[8:9], v[20:21] op_sel:[0,1,0] op_sel_hi:[1,1,1]
    v_lshlrev_b32 v26, 16, v112
    v_and_b32 v27, s87, v112
    v_pk_fma_f32 v[14:15], v[26:27], v[10:11], v[14:15] op_sel:[0,0,0] op_sel_hi:[1,0,1]
    v_lshlrev_b32 v28, 16, v113
    v_and_b32 v29, s87, v113
    v_pk_fma_f32 v[16:17], v[28:29], v[10:11], v[16:17] op_sel:[0,0,0] op_sel_hi:[1,0,1]
    v_lshlrev_b32 v30, 16, v114
    v_and_b32 v31, s87, v114
    v_pk_fma_f32 v[18:19], v[30:31], v[10:11], v[18:19] op_sel:[0,0,0] op_sel_hi:[1,0,1]
    v_lshlrev_b32 v32, 16, v115
    v_and_b32 v33, s87, v115
    v_pk_fma_f32 v[20:21], v[32:33], v[10:11], v[20:21] op_sel:[0,0,0] op_sel_hi:[1,0,1]
    s_waitcnt vmcnt(9)
    buffer_load_dwordx4 v[84:87], v1, s[4:7], s25 offen offset:1024 nt
    v_lshlrev_b32 v26, 16, v116
    v_and_b32 v27, s87, v116
    v_pk_fma_f32 v[14:15], v[26:27], v[10:11], v[14:15] op_sel:[0,1,0] op_sel_hi:[1,1,1]
    v_lshlrev_b32 v28, 16, v117
    v_and_b32 v29, s87, v117
    v_pk_fma_f32 v[16:17], v[28:29], v[10:11], v[16:17] op_sel:[0,1,0] op_sel_hi:[1,1,1]
    v_lshlrev_b32 v30, 16, v118
    v_and_b32 v31, s87, v118
    v_pk_fma_f32 v[18:19], v[30:31], v[10:11], v[18:19] op_sel:[0,1,0] op_sel_hi:[1,1,1]
    v_lshlrev_b32 v32, 16, v119
    v_and_b32 v33, s87, v119
    v_pk_fma_f32 v[20:21], v[32:33], v[10:11], v[20:21] op_sel:[0,1,0] op_sel_hi:[1,1,1]
    v_lshlrev_b32 v26, 16, v120
    v_and_b32 v27, s87, v120
    v_pk_fma_f32 v[14:15], v[26:27], v[12:13], v[14:15] op_sel:[0,0,0] op_sel_hi:[1,0,1]
    v_lshlrev_b32 v28, 16, v121
    v_and_b32 v29, s87, v121
    v_pk_fma_f32 v[16:17], v[28:29], v[12:13], v[16:17] op_sel:[0,0,0] op_sel_hi:[1,0,1]
    v_lshlrev_b32 v30, 16, v122
    v_and_b32 v31, s87, v122
    v_pk_fma_f32 v[18:19], v[30:31], v[12:13], v[18:19] op_sel:[0,0,0] op_sel_hi:[1,0,1]
    v_lshlrev_b32 v32, 16, v123
    v_and_b32 v33, s87, v123
    v_pk_fma_f32 v[20:21], v[32:33], v[12:13], v[20:21] op_sel:[0,0,0] op_sel_hi:[1,0,1]
    v_lshlrev_b32 v26, 16, v124
    v_and_b32 v27, s87, v124
    v_pk_fma_f32 v[14:15], v[26:27], v[12:13], v[14:15] op_sel:[0,1,0] op_sel_hi:[1,1,1]
    v_lshlrev_b32 v28, 16, v125
    v_and_b32 v29, s87, v125
    v_pk_fma_f32 v[16:17], v[28:29], v[12:13], v[16:17] op_sel:[0,1,0] op_sel_hi:[1,1,1]
    v_lshlrev_b32 v30, 16, v126
    v_and_b32 v31, s87, v126
    v_pk_fma_f32 v[18:19], v[30:31], v[12:13], v[18:19] op_sel:[0,1,0] op_sel_hi:[1,1,1]
    v_lshlrev_b32 v32, 16, v127
    v_and_b32 v33, s87, v127
    v_pk_fma_f32 v[20:21], v[32:33], v[12:13], v[20:21] op_sel:[0,1,0] op_sel_hi:[1,1,1]
    s_waitcnt vmcnt(9)
    buffer_load_dwordx4 v[88:91], v1, s[4:7], s25 offen offset:2048 nt
    v_dot2_f32_bf16 v6, v128, v2, 0
    v_dot2_f32_bf16 v7, v132, v2, 0
    v_dot2_f32_bf16 v6, v129, v3, v6
    v_dot2_f32_bf16 v7, v133, v3, v7
    v_dot2_f32_bf16 v6, v130, v4, v6
    v_dot2_f32_bf16 v7, v134, v4, v7
    v_dot2_f32_bf16 v6, v131, v5, v6
    v_dot2_f32_bf16 v7, v135, v5, v7
    s_waitcnt vmcnt(9)
    buffer_load_dwordx4 v[92:95], v1, s[4:7], s25 offen offset:3072 nt
    v_dot2_f32_bf16 v8, v136, v2, 0
    v_dot2_f32_bf16 v9, v140, v2, 0
    v_dot2_f32_bf16 v8, v137, v3, v8
    v_dot2_f32_bf16 v9, v141, v3, v9
    v_dot2_f32_bf16 v8, v138, v4, v8
    v_dot2_f32_bf16 v9, v142, v4, v9
    v_dot2_f32_bf16 v8, v139, v5, v8
    v_dot2_f32_bf16 v9, v143, v5, v9
    s_waitcnt vmcnt(9)
    buffer_load_dwordx4 v[96:99], v1, s[8:11], s24 offen offset:0 nt
    v_dot2_f32_bf16 v10, v144, v2, 0
    v_dot2_f32_bf16 v11, v148, v2, 0
    v_dot2_f32_bf16 v10, v145, v3, v10
    v_dot2_f32_bf16 v11, v149, v3, v11
    v_dot2_f32_bf16 v10, v146, v4, v10
    v_dot2_f32_bf16 v11, v150, v4, v11
    v_dot2_f32_bf16 v10, v147, v5, v10
    v_dot2_f32_bf16 v11, v151, v5, v11
    s_waitcnt vmcnt(9)
    buffer_load_dwordx4 v[100:103], v1, s[8:11], s24 offen offset:1024 nt
    v_dot2_f32_bf16 v12, v152, v2, 0
    v_dot2_f32_bf16 v13, v156, v2, 0
    v_dot2_f32_bf16 v12, v153, v3, v12
    v_dot2_f32_bf16 v13, v157, v3, v13
    v_dot2_f32_bf16 v12, v154, v4, v12
    v_dot2_f32_bf16 v13, v158, v4, v13
    v_dot2_f32_bf16 v12, v155, v5, v12
    v_dot2_f32_bf16 v13, v159, v5, v13
    s_waitcnt vmcnt(9)
    buffer_load_dwordx4 v[104:107], v1, s[8:11], s24 offen offset:2048 nt
    v_add_f32_dpp v6, v6, v6 row_ror:8 row_mask:0xf bank_mask:0xf
    v_add_f32_dpp v7, v7, v7 row_ror:8 row_mask:0xf bank_mask:0xf
    v_add_f32_dpp v8, v8, v8 row_ror:8 row_mask:0xf bank_mask:0xf
    v_add_f32_dpp v9, v9, v9 row_ror:8 row_mask:0xf bank_mask:0xf
    v_add_f32_dpp v10, v10, v10 row_ror:8 row_mask:0xf bank_mask:0xf
    v_add_f32_dpp v11, v11, v11 row_ror:8 row_mask:0xf bank_mask:0xf
    v_add_f32_dpp v12, v12, v12 row_ror:8 row_mask:0xf bank_mask:0xf
    v_add_f32_dpp v13, v13, v13 row_ror:8 row_mask:0xf bank_mask:0xf
    v_add_f32_dpp v6, v6, v6 row_ror:4 row_mask:0xf bank_mask:0xf
    v_add_f32_dpp v7, v7, v7 row_ror:4 row_mask:0xf bank_mask:0xf
    v_add_f32_dpp v8, v8, v8 row_ror:4 row_mask:0xf bank_mask:0xf
    v_add_f32_dpp v9, v9, v9 row_ror:4 row_mask:0xf bank_mask:0xf
    v_add_f32_dpp v10, v10, v10 row_ror:4 row_mask:0xf bank_mask:0xf
    v_add_f32_dpp v11, v11, v11 row_ror:4 row_mask:0xf bank_mask:0xf
    v_add_f32_dpp v12, v12, v12 row_ror:4 row_mask:0xf bank_mask:0xf
    v_add_f32_dpp v13, v13, v13 row_ror:4 row_mask:0xf bank_mask:0xf
    v_add_f32_dpp v6, v6, v6 row_ror:2 row_mask:0xf bank_mask:0xf
    v_add_f32_dpp v7, v7, v7 row_ror:2 row_mask:0xf bank_mask:0xf
    v_add_f32_dpp v8, v8, v8 row_ror:2 row_mask:0xf bank_mask:0xf
    v_add_f32_dpp v9, v9, v9 row_ror:2 row_mask:0xf bank_mask:0xf
    v_add_f32_dpp v10, v10, v10 row_ror:2 row_mask:0xf bank_mask:0xf
    v_add_f32_dpp v11, v11, v11 row_ror:2 row_mask:0xf bank_mask:0xf
    v_add_f32_dpp v12, v12, v12 row_ror:2 row_mask:0xf bank_mask:0xf
    v_add_f32_dpp v13, v13, v13 row_ror:2 row_mask:0xf bank_mask:0xf
    v_add_f32_dpp v6, v6, v6 row_ror:1 row_mask:0xf bank_mask:0xf
    v_add_f32_dpp v7, v7, v7 row_ror:1 row_mask:0xf bank_mask:0xf
    v_add_f32_dpp v8, v8, v8 row_ror:1 row_mask:0xf bank_mask:0xf
    v_add_f32_dpp v9, v9, v9 row_ror:1 row_mask:0xf bank_mask:0xf
    v_add_f32_dpp v10, v10, v10 row_ror:1 row_mask:0xf bank_mask:0xf
    v_add_f32_dpp v11, v11, v11 row_ror:1 row_mask:0xf bank_mask:0xf
    v_add_f32_dpp v12, v12, v12 row_ror:1 row_mask:0xf bank_mask:0xf
    v_add_f32_dpp v13, v13, v13 row_ror:1 row_mask:0xf bank_mask:0xf
    v_max3_f32 v25, v6, v7, v8
    v_max3_f32 v24, v9, v10, v11
    v_max3_f32 v25, v25, v12, v13
    v_max_f32 v25, v25, v24
    v_mul_f32 v25, s86, v25
    v_max_f32 v25, v25, v22
    v_sub_f32 v24, v22, v25
    v_mov_b32 v22, v25
    v_exp_f32 v24, v24
    v_fma_f32 v6, v6, s86, -v22
    v_fma_f32 v7, v7, s86, -v22
    v_fma_f32 v8, v8, s86, -v22
    v_fma_f32 v9, v9, s86, -v22
    v_fma_f32 v10, v10, s86, -v22
    v_fma_f32 v11, v11, s86, -v22
    v_fma_f32 v12, v12, s86, -v22
    v_fma_f32 v13, v13, s86, -v22
    v_exp_f32 v6, v6
    v_exp_f32 v7, v7
    v_exp_f32 v8, v8
    v_exp_f32 v9, v9
    v_exp_f32 v10, v10
    v_exp_f32 v11, v11
    v_exp_f32 v12, v12
    v_exp_f32 v13, v13
    v_pk_mul_f32 v[14:15], v[14:15], v[24:25] op_sel:[0,0] op_sel_hi:[1,0]
    v_pk_mul_f32 v[16:17], v[16:17], v[24:25] op_sel:[0,0] op_sel_hi:[1,0]
    v_pk_mul_f32 v[18:19], v[18:19], v[24:25] op_sel:[0,0] op_sel_hi:[1,0]
    v_pk_mul_f32 v[20:21], v[20:21], v[24:25] op_sel:[0,0] op_sel_hi:[1,0]
    v_fma_f32 v23, v23, v24, v6
    v_add_f32 v25, v7, v8
    v_add_f32 v26, v9, v10
    v_add_f32 v23, v23, v11
    v_add_f32 v25, v25, v12
    v_add_f32 v26, v26, v13
    v_add_f32 v23, v23, v25
    v_add_f32 v23, v23, v26
    v_lshlrev_b32 v26, 16, v160
    v_and_b32 v27, s87, v160
    v_pk_fma_f32 v[14:15], v[26:27], v[6:7], v[14:15] op_sel:[0,0,0] op_sel_hi:[1,0,1]
    v_lshlrev_b32 v28, 16, v161
    v_and_b32 v29, s87, v161
    v_pk_fma_f32 v[16:17], v[28:29], v[6:7], v[16:17] op_sel:[0,0,0] op_sel_hi:[1,0,1]
    v_lshlrev_b32 v30, 16, v162
    v_and_b32 v31, s87, v162
    v_pk_fma_f32 v[18:19], v[30:31], v[6:7], v[18:19] op_sel:[0,0,0] op_sel_hi:[1,0,1]
    v_lshlrev_b32 v32, 16, v163
    v_and_b32 v33, s87, v163
    v_pk_fma_f32 v[20:21], v[32:33], v[6:7], v[20:21] op_sel:[0,0,0] op_sel_hi:[1,0,1]
    v_lshlrev_b32 v26, 16, v164
    v_and_b32 v27, s87, v164
    v_pk_fma_f32 v[14:15], v[26:27], v[6:7], v[14:15] op_sel:[0,1,0] op_sel_hi:[1,1,1]
    v_lshlrev_b32 v28, 16, v165
    v_and_b32 v29, s87, v165
    v_pk_fma_f32 v[16:17], v[28:29], v[6:7], v[16:17] op_sel:[0,1,0] op_sel_hi:[1,1,1]
    v_lshlrev_b32 v30, 16, v166
    v_and_b32 v31, s87, v166
    v_pk_fma_f32 v[18:19], v[30:31], v[6:7], v[18:19] op_sel:[0,1,0] op_sel_hi:[1,1,1]
    v_lshlrev_b32 v32, 16, v167
    v_and_b32 v33, s87, v167
    v_pk_fma_f32 v[20:21], v[32:33], v[6:7], v[20:21] op_sel:[0,1,0] op_sel_hi:[1,1,1]
    s_waitcnt vmcnt(9)
    buffer_load_dwordx4 v[108:111], v1, s[8:11], s24 offen offset:3072 nt
    v_lshlrev_b32 v26, 16, v168
    v_and_b32 v27, s87, v168
    v_pk_fma_f32 v[14:15], v[26:27], v[8:9], v[14:15] op_sel:[0,0,0] op_sel_hi:[1,0,1]
    v_lshlrev_b32 v28, 16, v169
    v_and_b32 v29, s87, v169
    v_pk_fma_f32 v[16:17], v[28:29], v[8:9], v[16:17] op_sel:[0,0,0] op_sel_hi:[1,0,1]
    v_lshlrev_b32 v30, 16, v170
    v_and_b32 v31, s87, v170
    v_pk_fma_f32 v[18:19], v[30:31], v[8:9], v[18:19] op_sel:[0,0,0] op_sel_hi:[1,0,1]
    v_lshlrev_b32 v32, 16, v171
    v_and_b32 v33, s87, v171
    v_pk_fma_f32 v[20:21], v[32:33], v[8:9], v[20:21] op_sel:[0,0,0] op_sel_hi:[1,0,1]
    v_lshlrev_b32 v26, 16, v172
    v_and_b32 v27, s87, v172
    v_pk_fma_f32 v[14:15], v[26:27], v[8:9], v[14:15] op_sel:[0,1,0] op_sel_hi:[1,1,1]
    v_lshlrev_b32 v28, 16, v173
    v_and_b32 v29, s87, v173
    v_pk_fma_f32 v[16:17], v[28:29], v[8:9], v[16:17] op_sel:[0,1,0] op_sel_hi:[1,1,1]
    v_lshlrev_b32 v30, 16, v174
    v_and_b32 v31, s87, v174
    v_pk_fma_f32 v[18:19], v[30:31], v[8:9], v[18:19] op_sel:[0,1,0] op_sel_hi:[1,1,1]
    v_lshlrev_b32 v32, 16, v175
    v_and_b32 v33, s87, v175
    v_pk_fma_f32 v[20:21], v[32:33], v[8:9], v[20:21] op_sel:[0,1,0] op_sel_hi:[1,1,1]
    v_lshlrev_b32 v26, 16, v176
    v_and_b32 v27, s87, v176
    v_pk_fma_f32 v[14:15], v[26:27], v[10:11], v[14:15] op_sel:[0,0,0] op_sel_hi:[1,0,1]
    v_lshlrev_b32 v28, 16, v177
    v_and_b32 v29, s87, v177
    v_pk_fma_f32 v[16:17], v[28:29], v[10:11], v[16:17] op_sel:[0,0,0] op_sel_hi:[1,0,1]
    v_lshlrev_b32 v30, 16, v178
    v_and_b32 v31, s87, v178
    v_pk_fma_f32 v[18:19], v[30:31], v[10:11], v[18:19] op_sel:[0,0,0] op_sel_hi:[1,0,1]
    v_lshlrev_b32 v32, 16, v179
    v_and_b32 v33, s87, v179
    v_pk_fma_f32 v[20:21], v[32:33], v[10:11], v[20:21] op_sel:[0,0,0] op_sel_hi:[1,0,1]
    s_waitcnt vmcnt(9)
    buffer_load_dwordx4 v[112:115], v1, s[8:11], s25 offen offset:0 nt
    v_lshlrev_b32 v26, 16, v180
    v_and_b32 v27, s87, v180
    v_pk_fma_f32 v[14:15], v[26:27], v[10:11], v[14:15] op_sel:[0,1,0] op_sel_hi:[1,1,1]
    v_lshlrev_b32 v28, 16, v181
    v_and_b32 v29, s87, v181
    v_pk_fma_f32 v[16:17], v[28:29], v[10:11], v[16:17] op_sel:[0,1,0] op_sel_hi:[1,1,1]
    v_lshlrev_b32 v30, 16, v182
    v_and_b32 v31, s87, v182
    v_pk_fma_f32 v[18:19], v[30:31], v[10:11], v[18:19] op_sel:[0,1,0] op_sel_hi:[1,1,1]
    v_lshlrev_b32 v32, 16, v183
    v_and_b32 v33, s87, v183
    v_pk_fma_f32 v[20:21], v[32:33], v[10:11], v[20:21] op_sel:[0,1,0] op_sel_hi:[1,1,1]
    v_lshlrev_b32 v26, 16, v184
    v_and_b32 v27, s87, v184
    v_pk_fma_f32 v[14:15], v[26:27], v[12:13], v[14:15] op_sel:[0,0,0] op_sel_hi:[1,0,1]
    v_lshlrev_b32 v28, 16, v185
    v_and_b32 v29, s87, v185
    v_pk_fma_f32 v[16:17], v[28:29], v[12:13], v[16:17] op_sel:[0,0,0] op_sel_hi:[1,0,1]
    v_lshlrev_b32 v30, 16, v186
    v_and_b32 v31, s87, v186
    v_pk_fma_f32 v[18:19], v[30:31], v[12:13], v[18:19] op_sel:[0,0,0] op_sel_hi:[1,0,1]
    v_lshlrev_b32 v32, 16, v187
    v_and_b32 v33, s87, v187
    v_pk_fma_f32 v[20:21], v[32:33], v[12:13], v[20:21] op_sel:[0,0,0] op_sel_hi:[1,0,1]
    s_waitcnt vmcnt(9)
    buffer_load_dwordx4 v[116:119], v1, s[8:11], s25 offen offset:1024 nt
    v_lshlrev_b32 v26, 16, v188
    v_and_b32 v27, s87, v188
    v_pk_fma_f32 v[14:15], v[26:27], v[12:13], v[14:15] op_sel:[0,1,0] op_sel_hi:[1,1,1]
    v_lshlrev_b32 v28, 16, v189
    v_and_b32 v29, s87, v189
    v_pk_fma_f32 v[16:17], v[28:29], v[12:13], v[16:17] op_sel:[0,1,0] op_sel_hi:[1,1,1]
    v_lshlrev_b32 v30, 16, v190
    v_and_b32 v31, s87, v190
    v_pk_fma_f32 v[18:19], v[30:31], v[12:13], v[18:19] op_sel:[0,1,0] op_sel_hi:[1,1,1]
    v_lshlrev_b32 v32, 16, v191
    v_and_b32 v33, s87, v191
    v_pk_fma_f32 v[20:21], v[32:33], v[12:13], v[20:21] op_sel:[0,1,0] op_sel_hi:[1,1,1]
    v_dot2_f32_bf16 v6, v192, v2, 0
    v_dot2_f32_bf16 v7, v196, v2, 0
    v_dot2_f32_bf16 v6, v193, v3, v6
    v_dot2_f32_bf16 v7, v197, v3, v7
    v_dot2_f32_bf16 v6, v194, v4, v6
    v_dot2_f32_bf16 v7, v198, v4, v7
    v_dot2_f32_bf16 v6, v195, v5, v6
    v_dot2_f32_bf16 v7, v199, v5, v7
    s_waitcnt vmcnt(9)
    buffer_load_dwordx4 v[120:123], v1, s[8:11], s25 offen offset:2048 nt
    v_dot2_f32_bf16 v8, v200, v2, 0
    v_dot2_f32_bf16 v9, v204, v2, 0
    v_dot2_f32_bf16 v8, v201, v3, v8
    v_dot2_f32_bf16 v9, v205, v3, v9
    v_dot2_f32_bf16 v8, v202, v4, v8
    v_dot2_f32_bf16 v9, v206, v4, v9
    v_dot2_f32_bf16 v8, v203, v5, v8
    v_dot2_f32_bf16 v9, v207, v5, v9
    s_waitcnt vmcnt(9)
    buffer_load_dwordx4 v[124:127], v1, s[8:11], s25 offen offset:3072 nt
    v_dot2_f32_bf16 v10, v208, v2, 0
    v_dot2_f32_bf16 v11, v212, v2, 0
    v_dot2_f32_bf16 v10, v209, v3, v10
    v_dot2_f32_bf16 v11, v213, v3, v11
    v_dot2_f32_bf16 v10, v210, v4, v10
    v_dot2_f32_bf16 v11, v214, v4, v11
    v_dot2_f32_bf16 v10, v211, v5, v10
    v_dot2_f32_bf16 v11, v215, v5, v11
    s_waitcnt vmcnt(9)
    buffer_load_dwordx4 v[128:131], v1, s[4:7], s26 offen offset:0 nt
    v_dot2_f32_bf16 v12, v216, v2, 0
    v_dot2_f32_bf16 v13, v220, v2, 0
    v_dot2_f32_bf16 v12, v217, v3, v12
    v_dot2_f32_bf16 v13, v221, v3, v13
    v_dot2_f32_bf16 v12, v218, v4, v12
    v_dot2_f32_bf16 v13, v222, v4, v13
    v_dot2_f32_bf16 v12, v219, v5, v12
    v_dot2_f32_bf16 v13, v223, v5, v13
    s_waitcnt vmcnt(9)
    buffer_load_dwordx4 v[132:135], v1, s[4:7], s26 offen offset:1024 nt
    v_add_f32_dpp v6, v6, v6 row_ror:8 row_mask:0xf bank_mask:0xf
    v_add_f32_dpp v7, v7, v7 row_ror:8 row_mask:0xf bank_mask:0xf
    v_add_f32_dpp v8, v8, v8 row_ror:8 row_mask:0xf bank_mask:0xf
    v_add_f32_dpp v9, v9, v9 row_ror:8 row_mask:0xf bank_mask:0xf
    v_add_f32_dpp v10, v10, v10 row_ror:8 row_mask:0xf bank_mask:0xf
    v_add_f32_dpp v11, v11, v11 row_ror:8 row_mask:0xf bank_mask:0xf
    v_add_f32_dpp v12, v12, v12 row_ror:8 row_mask:0xf bank_mask:0xf
    v_add_f32_dpp v13, v13, v13 row_ror:8 row_mask:0xf bank_mask:0xf
    v_add_f32_dpp v6, v6, v6 row_ror:4 row_mask:0xf bank_mask:0xf
    v_add_f32_dpp v7, v7, v7 row_ror:4 row_mask:0xf bank_mask:0xf
    v_add_f32_dpp v8, v8, v8 row_ror:4 row_mask:0xf bank_mask:0xf
    v_add_f32_dpp v9, v9, v9 row_ror:4 row_mask:0xf bank_mask:0xf
    v_add_f32_dpp v10, v10, v10 row_ror:4 row_mask:0xf bank_mask:0xf
    v_add_f32_dpp v11, v11, v11 row_ror:4 row_mask:0xf bank_mask:0xf
    v_add_f32_dpp v12, v12, v12 row_ror:4 row_mask:0xf bank_mask:0xf
    v_add_f32_dpp v13, v13, v13 row_ror:4 row_mask:0xf bank_mask:0xf
    v_add_f32_dpp v6, v6, v6 row_ror:2 row_mask:0xf bank_mask:0xf
    v_add_f32_dpp v7, v7, v7 row_ror:2 row_mask:0xf bank_mask:0xf
    v_add_f32_dpp v8, v8, v8 row_ror:2 row_mask:0xf bank_mask:0xf
    v_add_f32_dpp v9, v9, v9 row_ror:2 row_mask:0xf bank_mask:0xf
    v_add_f32_dpp v10, v10, v10 row_ror:2 row_mask:0xf bank_mask:0xf
    v_add_f32_dpp v11, v11, v11 row_ror:2 row_mask:0xf bank_mask:0xf
    v_add_f32_dpp v12, v12, v12 row_ror:2 row_mask:0xf bank_mask:0xf
    v_add_f32_dpp v13, v13, v13 row_ror:2 row_mask:0xf bank_mask:0xf
    v_add_f32_dpp v6, v6, v6 row_ror:1 row_mask:0xf bank_mask:0xf
    v_add_f32_dpp v7, v7, v7 row_ror:1 row_mask:0xf bank_mask:0xf
    v_add_f32_dpp v8, v8, v8 row_ror:1 row_mask:0xf bank_mask:0xf
    v_add_f32_dpp v9, v9, v9 row_ror:1 row_mask:0xf bank_mask:0xf
    v_add_f32_dpp v10, v10, v10 row_ror:1 row_mask:0xf bank_mask:0xf
    v_add_f32_dpp v11, v11, v11 row_ror:1 row_mask:0xf bank_mask:0xf
    v_add_f32_dpp v12, v12, v12 row_ror:1 row_mask:0xf bank_mask:0xf
    v_add_f32_dpp v13, v13, v13 row_ror:1 row_mask:0xf bank_mask:0xf
    v_max3_f32 v25, v6, v7, v8
    v_max3_f32 v24, v9, v10, v11
    v_max3_f32 v25, v25, v12, v13
    v_max_f32 v25, v25, v24
    v_mul_f32 v25, s86, v25
    v_max_f32 v25, v25, v22
    v_sub_f32 v24, v22, v25
    v_mov_b32 v22, v25
    v_exp_f32 v24, v24
    v_fma_f32 v6, v6, s86, -v22
    v_fma_f32 v7, v7, s86, -v22
    v_fma_f32 v8, v8, s86, -v22
    v_fma_f32 v9, v9, s86, -v22
    v_fma_f32 v10, v10, s86, -v22
    v_fma_f32 v11, v11, s86, -v22
    v_fma_f32 v12, v12, s86, -v22
    v_fma_f32 v13, v13, s86, -v22
    v_exp_f32 v6, v6
    v_exp_f32 v7, v7
    v_exp_f32 v8, v8
    v_exp_f32 v9, v9
    v_exp_f32 v10, v10
    v_exp_f32 v11, v11
    v_exp_f32 v12, v12
    v_exp_f32 v13, v13
    v_pk_mul_f32 v[14:15], v[14:15], v[24:25] op_sel:[0,0] op_sel_hi:[1,0]
    v_pk_mul_f32 v[16:17], v[16:17], v[24:25] op_sel:[0,0] op_sel_hi:[1,0]
    v_pk_mul_f32 v[18:19], v[18:19], v[24:25] op_sel:[0,0] op_sel_hi:[1,0]
    v_pk_mul_f32 v[20:21], v[20:21], v[24:25] op_sel:[0,0] op_sel_hi:[1,0]
    v_fma_f32 v23, v23, v24, v6
    v_add_f32 v25, v7, v8
    v_add_f32 v26, v9, v10
    v_add_f32 v23, v23, v11
    v_add_f32 v25, v25, v12
    v_add_f32 v26, v26, v13
    v_add_f32 v23, v23, v25
    v_add_f32 v23, v23, v26
    v_lshlrev_b32 v26, 16, v224
    v_and_b32 v27, s87, v224
    v_pk_fma_f32 v[14:15], v[26:27], v[6:7], v[14:15] op_sel:[0,0,0] op_sel_hi:[1,0,1]
    v_lshlrev_b32 v28, 16, v225
    v_and_b32 v29, s87, v225
    v_pk_fma_f32 v[16:17], v[28:29], v[6:7], v[16:17] op_sel:[0,0,0] op_sel_hi:[1,0,1]
    v_lshlrev_b32 v30, 16, v226
    v_and_b32 v31, s87, v226
    v_pk_fma_f32 v[18:19], v[30:31], v[6:7], v[18:19] op_sel:[0,0,0] op_sel_hi:[1,0,1]
    v_lshlrev_b32 v32, 16, v227
    v_and_b32 v33, s87, v227
    v_pk_fma_f32 v[20:21], v[32:33], v[6:7], v[20:21] op_sel:[0,0,0] op_sel_hi:[1,0,1]
    s_waitcnt vmcnt(9)
    buffer_load_dwordx4 v[136:139], v1, s[4:7], s26 offen offset:2048 nt
    v_lshlrev_b32 v26, 16, v228
    v_and_b32 v27, s87, v228
    v_pk_fma_f32 v[14:15], v[26:27], v[6:7], v[14:15] op_sel:[0,1,0] op_sel_hi:[1,1,1]
    v_lshlrev_b32 v28, 16, v229
    v_and_b32 v29, s87, v229
    v_pk_fma_f32 v[16:17], v[28:29], v[6:7], v[16:17] op_sel:[0,1,0] op_sel_hi:[1,1,1]
    v_lshlrev_b32 v30, 16, v230
    v_and_b32 v31, s87, v230
    v_pk_fma_f32 v[18:19], v[30:31], v[6:7], v[18:19] op_sel:[0,1,0] op_sel_hi:[1,1,1]
    v_lshlrev_b32 v32, 16, v231
    v_and_b32 v33, s87, v231
    v_pk_fma_f32 v[20:21], v[32:33], v[6:7], v[20:21] op_sel:[0,1,0] op_sel_hi:[1,1,1]
    v_lshlrev_b32 v26, 16, v232
    v_and_b32 v27, s87, v232
    v_pk_fma_f32 v[14:15], v[26:27], v[8:9], v[14:15] op_sel:[0,0,0] op_sel_hi:[1,0,1]
    v_lshlrev_b32 v28, 16, v233
    v_and_b32 v29, s87, v233
    v_pk_fma_f32 v[16:17], v[28:29], v[8:9], v[16:17] op_sel:[0,0,0] op_sel_hi:[1,0,1]
    v_lshlrev_b32 v30, 16, v234
    v_and_b32 v31, s87, v234
    v_pk_fma_f32 v[18:19], v[30:31], v[8:9], v[18:19] op_sel:[0,0,0] op_sel_hi:[1,0,1]
    v_lshlrev_b32 v32, 16, v235
    v_and_b32 v33, s87, v235
    v_pk_fma_f32 v[20:21], v[32:33], v[8:9], v[20:21] op_sel:[0,0,0] op_sel_hi:[1,0,1]
    v_lshlrev_b32 v26, 16, v236
    v_and_b32 v27, s87, v236
    v_pk_fma_f32 v[14:15], v[26:27], v[8:9], v[14:15] op_sel:[0,1,0] op_sel_hi:[1,1,1]
    v_lshlrev_b32 v28, 16, v237
    v_and_b32 v29, s87, v237
    v_pk_fma_f32 v[16:17], v[28:29], v[8:9], v[16:17] op_sel:[0,1,0] op_sel_hi:[1,1,1]
    v_lshlrev_b32 v30, 16, v238
    v_and_b32 v31, s87, v238
    v_pk_fma_f32 v[18:19], v[30:31], v[8:9], v[18:19] op_sel:[0,1,0] op_sel_hi:[1,1,1]
    v_lshlrev_b32 v32, 16, v239
    v_and_b32 v33, s87, v239
    v_pk_fma_f32 v[20:21], v[32:33], v[8:9], v[20:21] op_sel:[0,1,0] op_sel_hi:[1,1,1]
    s_waitcnt vmcnt(9)
    buffer_load_dwordx4 v[140:143], v1, s[4:7], s26 offen offset:3072 nt
    v_lshlrev_b32 v26, 16, v240
    v_and_b32 v27, s87, v240
    v_pk_fma_f32 v[14:15], v[26:27], v[10:11], v[14:15] op_sel:[0,0,0] op_sel_hi:[1,0,1]
    v_lshlrev_b32 v28, 16, v241
    v_and_b32 v29, s87, v241
    v_pk_fma_f32 v[16:17], v[28:29], v[10:11], v[16:17] op_sel:[0,0,0] op_sel_hi:[1,0,1]
    v_lshlrev_b32 v30, 16, v242
    v_and_b32 v31, s87, v242
    v_pk_fma_f32 v[18:19], v[30:31], v[10:11], v[18:19] op_sel:[0,0,0] op_sel_hi:[1,0,1]
    v_lshlrev_b32 v32, 16, v243
    v_and_b32 v33, s87, v243
    v_pk_fma_f32 v[20:21], v[32:33], v[10:11], v[20:21] op_sel:[0,0,0] op_sel_hi:[1,0,1]
    v_lshlrev_b32 v26, 16, v244
    v_and_b32 v27, s87, v244
    v_pk_fma_f32 v[14:15], v[26:27], v[10:11], v[14:15] op_sel:[0,1,0] op_sel_hi:[1,1,1]
    v_lshlrev_b32 v28, 16, v245
    v_and_b32 v29, s87, v245
    v_pk_fma_f32 v[16:17], v[28:29], v[10:11], v[16:17] op_sel:[0,1,0] op_sel_hi:[1,1,1]
    v_lshlrev_b32 v30, 16, v246
    v_and_b32 v31, s87, v246
    v_pk_fma_f32 v[18:19], v[30:31], v[10:11], v[18:19] op_sel:[0,1,0] op_sel_hi:[1,1,1]
    v_lshlrev_b32 v32, 16, v247
    v_and_b32 v33, s87, v247
    v_pk_fma_f32 v[20:21], v[32:33], v[10:11], v[20:21] op_sel:[0,1,0] op_sel_hi:[1,1,1]
    s_waitcnt vmcnt(9)
    buffer_load_dwordx4 v[144:147], v1, s[4:7], s27 offen offset:0 nt
    v_lshlrev_b32 v26, 16, v248
    v_and_b32 v27, s87, v248
    v_pk_fma_f32 v[14:15], v[26:27], v[12:13], v[14:15] op_sel:[0,0,0] op_sel_hi:[1,0,1]
    v_lshlrev_b32 v28, 16, v249
    v_and_b32 v29, s87, v249
    v_pk_fma_f32 v[16:17], v[28:29], v[12:13], v[16:17] op_sel:[0,0,0] op_sel_hi:[1,0,1]
    v_lshlrev_b32 v30, 16, v250
    v_and_b32 v31, s87, v250
    v_pk_fma_f32 v[18:19], v[30:31], v[12:13], v[18:19] op_sel:[0,0,0] op_sel_hi:[1,0,1]
    v_lshlrev_b32 v32, 16, v251
    v_and_b32 v33, s87, v251
    v_pk_fma_f32 v[20:21], v[32:33], v[12:13], v[20:21] op_sel:[0,0,0] op_sel_hi:[1,0,1]
    v_lshlrev_b32 v26, 16, v252
    v_and_b32 v27, s87, v252
    v_pk_fma_f32 v[14:15], v[26:27], v[12:13], v[14:15] op_sel:[0,1,0] op_sel_hi:[1,1,1]
    v_lshlrev_b32 v28, 16, v253
    v_and_b32 v29, s87, v253
    v_pk_fma_f32 v[16:17], v[28:29], v[12:13], v[16:17] op_sel:[0,1,0] op_sel_hi:[1,1,1]
    v_lshlrev_b32 v30, 16, v254
    v_and_b32 v31, s87, v254
    v_pk_fma_f32 v[18:19], v[30:31], v[12:13], v[18:19] op_sel:[0,1,0] op_sel_hi:[1,1,1]
    v_lshlrev_b32 v32, 16, v255
    v_and_b32 v33, s87, v255
    v_pk_fma_f32 v[20:21], v[32:33], v[12:13], v[20:21] op_sel:[0,1,0] op_sel_hi:[1,1,1]
    s_waitcnt vmcnt(9)
    buffer_load_dwordx4 v[148:151], v1, s[4:7], s27 offen offset:1024 nt
    v_dot2_f32_bf16 v6, v64, v2, 0
    v_dot2_f32_bf16 v7, v68, v2, 0
    v_dot2_f32_bf16 v6, v65, v3, v6
    v_dot2_f32_bf16 v7, v69, v3, v7
    v_dot2_f32_bf16 v6, v66, v4, v6
    v_dot2_f32_bf16 v7, v70, v4, v7
    v_dot2_f32_bf16 v6, v67, v5, v6
    v_dot2_f32_bf16 v7, v71, v5, v7
    s_waitcnt vmcnt(9)
    buffer_load_dwordx4 v[152:155], v1, s[4:7], s27 offen offset:2048 nt
    v_dot2_f32_bf16 v8, v72, v2, 0
    v_dot2_f32_bf16 v9, v76, v2, 0
    v_dot2_f32_bf16 v8, v73, v3, v8
    v_dot2_f32_bf16 v9, v77, v3, v9
    v_dot2_f32_bf16 v8, v74, v4, v8
    v_dot2_f32_bf16 v9, v78, v4, v9
    v_dot2_f32_bf16 v8, v75, v5, v8
    v_dot2_f32_bf16 v9, v79, v5, v9
    s_waitcnt vmcnt(9)
    buffer_load_dwordx4 v[156:159], v1, s[4:7], s27 offen offset:3072 nt
    v_dot2_f32_bf16 v10, v80, v2, 0
    v_dot2_f32_bf16 v11, v84, v2, 0
    v_dot2_f32_bf16 v10, v81, v3, v10
    v_dot2_f32_bf16 v11, v85, v3, v11
    v_dot2_f32_bf16 v10, v82, v4, v10
    v_dot2_f32_bf16 v11, v86, v4, v11
    v_dot2_f32_bf16 v10, v83, v5, v10
    v_dot2_f32_bf16 v11, v87, v5, v11
    s_waitcnt vmcnt(9)
    buffer_load_dwordx4 v[160:163], v1, s[8:11], s26 offen offset:0 nt
    v_dot2_f32_bf16 v12, v88, v2, 0
    v_dot2_f32_bf16 v13, v92, v2, 0
    v_dot2_f32_bf16 v12, v89, v3, v12
    v_dot2_f32_bf16 v13, v93, v3, v13
    v_dot2_f32_bf16 v12, v90, v4, v12
    v_dot2_f32_bf16 v13, v94, v4, v13
    v_dot2_f32_bf16 v12, v91, v5, v12
    v_dot2_f32_bf16 v13, v95, v5, v13
    v_add_f32_dpp v6, v6, v6 row_ror:8 row_mask:0xf bank_mask:0xf
    v_add_f32_dpp v7, v7, v7 row_ror:8 row_mask:0xf bank_mask:0xf
    v_add_f32_dpp v8, v8, v8 row_ror:8 row_mask:0xf bank_mask:0xf
    v_add_f32_dpp v9, v9, v9 row_ror:8 row_mask:0xf bank_mask:0xf
    v_add_f32_dpp v10, v10, v10 row_ror:8 row_mask:0xf bank_mask:0xf
    v_add_f32_dpp v11, v11, v11 row_ror:8 row_mask:0xf bank_mask:0xf
    v_add_f32_dpp v12, v12, v12 row_ror:8 row_mask:0xf bank_mask:0xf
    v_add_f32_dpp v13, v13, v13 row_ror:8 row_mask:0xf bank_mask:0xf
    v_add_f32_dpp v6, v6, v6 row_ror:4 row_mask:0xf bank_mask:0xf
    v_add_f32_dpp v7, v7, v7 row_ror:4 row_mask:0xf bank_mask:0xf
    v_add_f32_dpp v8, v8, v8 row_ror:4 row_mask:0xf bank_mask:0xf
    v_add_f32_dpp v9, v9, v9 row_ror:4 row_mask:0xf bank_mask:0xf
    v_add_f32_dpp v10, v10, v10 row_ror:4 row_mask:0xf bank_mask:0xf
    v_add_f32_dpp v11, v11, v11 row_ror:4 row_mask:0xf bank_mask:0xf
    v_add_f32_dpp v12, v12, v12 row_ror:4 row_mask:0xf bank_mask:0xf
    v_add_f32_dpp v13, v13, v13 row_ror:4 row_mask:0xf bank_mask:0xf
    v_add_f32_dpp v6, v6, v6 row_ror:2 row_mask:0xf bank_mask:0xf
    v_add_f32_dpp v7, v7, v7 row_ror:2 row_mask:0xf bank_mask:0xf
    v_add_f32_dpp v8, v8, v8 row_ror:2 row_mask:0xf bank_mask:0xf
    v_add_f32_dpp v9, v9, v9 row_ror:2 row_mask:0xf bank_mask:0xf
    v_add_f32_dpp v10, v10, v10 row_ror:2 row_mask:0xf bank_mask:0xf
    v_add_f32_dpp v11, v11, v11 row_ror:2 row_mask:0xf bank_mask:0xf
    v_add_f32_dpp v12, v12, v12 row_ror:2 row_mask:0xf bank_mask:0xf
    v_add_f32_dpp v13, v13, v13 row_ror:2 row_mask:0xf bank_mask:0xf
    v_add_f32_dpp v6, v6, v6 row_ror:1 row_mask:0xf bank_mask:0xf
    v_add_f32_dpp v7, v7, v7 row_ror:1 row_mask:0xf bank_mask:0xf
    v_add_f32_dpp v8, v8, v8 row_ror:1 row_mask:0xf bank_mask:0xf
    v_add_f32_dpp v9, v9, v9 row_ror:1 row_mask:0xf bank_mask:0xf
    v_add_f32_dpp v10, v10, v10 row_ror:1 row_mask:0xf bank_mask:0xf
    v_add_f32_dpp v11, v11, v11 row_ror:1 row_mask:0xf bank_mask:0xf
    v_add_f32_dpp v12, v12, v12 row_ror:1 row_mask:0xf bank_mask:0xf
    v_add_f32_dpp v13, v13, v13 row_ror:1 row_mask:0xf bank_mask:0xf
    v_max3_f32 v25, v6, v7, v8
    v_max3_f32 v24, v9, v10, v11
    v_max3_f32 v25, v25, v12, v13
    v_max_f32 v25, v25, v24
    v_mul_f32 v25, s86, v25
    v_max_f32 v25, v25, v22
    v_sub_f32 v24, v22, v25
    v_mov_b32 v22, v25
    v_exp_f32 v24, v24
    v_fma_f32 v6, v6, s86, -v22
    v_fma_f32 v7, v7, s86, -v22
    v_fma_f32 v8, v8, s86, -v22
    v_fma_f32 v9, v9, s86, -v22
    v_fma_f32 v10, v10, s86, -v22
    v_fma_f32 v11, v11, s86, -v22
    v_fma_f32 v12, v12, s86, -v22
    v_fma_f32 v13, v13, s86, -v22
    v_exp_f32 v6, v6
    v_exp_f32 v7, v7
    v_exp_f32 v8, v8
    v_exp_f32 v9, v9
    v_exp_f32 v10, v10
    v_exp_f32 v11, v11
    v_exp_f32 v12, v12
    v_exp_f32 v13, v13
    v_pk_mul_f32 v[14:15], v[14:15], v[24:25] op_sel:[0,0] op_sel_hi:[1,0]
    v_pk_mul_f32 v[16:17], v[16:17], v[24:25] op_sel:[0,0] op_sel_hi:[1,0]
    v_pk_mul_f32 v[18:19], v[18:19], v[24:25] op_sel:[0,0] op_sel_hi:[1,0]
    v_pk_mul_f32 v[20:21], v[20:21], v[24:25] op_sel:[0,0] op_sel_hi:[1,0]
    v_fma_f32 v23, v23, v24, v6
    v_add_f32 v25, v7, v8
    v_add_f32 v26, v9, v10
    v_add_f32 v23, v23, v11
    v_add_f32 v25, v25, v12
    v_add_f32 v26, v26, v13
    v_add_f32 v23, v23, v25
    v_add_f32 v23, v23, v26
    v_lshlrev_b32 v26, 16, v96
    v_and_b32 v27, s87, v96
    v_pk_fma_f32 v[14:15], v[26:27], v[6:7], v[14:15] op_sel:[0,0,0] op_sel_hi:[1,0,1]
    v_lshlrev_b32 v28, 16, v97
    v_and_b32 v29, s87, v97
    v_pk_fma_f32 v[16:17], v[28:29], v[6:7], v[16:17] op_sel:[0,0,0] op_sel_hi:[1,0,1]
    v_lshlrev_b32 v30, 16, v98
    v_and_b32 v31, s87, v98
    v_pk_fma_f32 v[18:19], v[30:31], v[6:7], v[18:19] op_sel:[0,0,0] op_sel_hi:[1,0,1]
    v_lshlrev_b32 v32, 16, v99
    v_and_b32 v33, s87, v99
    v_pk_fma_f32 v[20:21], v[32:33], v[6:7], v[20:21] op_sel:[0,0,0] op_sel_hi:[1,0,1]
    s_waitcnt vmcnt(9)
    buffer_load_dwordx4 v[164:167], v1, s[8:11], s26 offen offset:1024 nt
    v_lshlrev_b32 v26, 16, v100
    v_and_b32 v27, s87, v100
    v_pk_fma_f32 v[14:15], v[26:27], v[6:7], v[14:15] op_sel:[0,1,0] op_sel_hi:[1,1,1]
    v_lshlrev_b32 v28, 16, v101
    v_and_b32 v29, s87, v101
    v_pk_fma_f32 v[16:17], v[28:29], v[6:7], v[16:17] op_sel:[0,1,0] op_sel_hi:[1,1,1]
    v_lshlrev_b32 v30, 16, v102
    v_and_b32 v31, s87, v102
    v_pk_fma_f32 v[18:19], v[30:31], v[6:7], v[18:19] op_sel:[0,1,0] op_sel_hi:[1,1,1]
    v_lshlrev_b32 v32, 16, v103
    v_and_b32 v33, s87, v103
    v_pk_fma_f32 v[20:21], v[32:33], v[6:7], v[20:21] op_sel:[0,1,0] op_sel_hi:[1,1,1]
    v_lshlrev_b32 v26, 16, v104
    v_and_b32 v27, s87, v104
    v_pk_fma_f32 v[14:15], v[26:27], v[8:9], v[14:15] op_sel:[0,0,0] op_sel_hi:[1,0,1]
    v_lshlrev_b32 v28, 16, v105
    v_and_b32 v29, s87, v105
    v_pk_fma_f32 v[16:17], v[28:29], v[8:9], v[16:17] op_sel:[0,0,0] op_sel_hi:[1,0,1]
    v_lshlrev_b32 v30, 16, v106
    v_and_b32 v31, s87, v106
    v_pk_fma_f32 v[18:19], v[30:31], v[8:9], v[18:19] op_sel:[0,0,0] op_sel_hi:[1,0,1]
    v_lshlrev_b32 v32, 16, v107
    v_and_b32 v33, s87, v107
    v_pk_fma_f32 v[20:21], v[32:33], v[8:9], v[20:21] op_sel:[0,0,0] op_sel_hi:[1,0,1]
    s_waitcnt vmcnt(9)
    buffer_load_dwordx4 v[168:171], v1, s[8:11], s26 offen offset:2048 nt
    v_lshlrev_b32 v26, 16, v108
    v_and_b32 v27, s87, v108
    v_pk_fma_f32 v[14:15], v[26:27], v[8:9], v[14:15] op_sel:[0,1,0] op_sel_hi:[1,1,1]
    v_lshlrev_b32 v28, 16, v109
    v_and_b32 v29, s87, v109
    v_pk_fma_f32 v[16:17], v[28:29], v[8:9], v[16:17] op_sel:[0,1,0] op_sel_hi:[1,1,1]
    v_lshlrev_b32 v30, 16, v110
    v_and_b32 v31, s87, v110
    v_pk_fma_f32 v[18:19], v[30:31], v[8:9], v[18:19] op_sel:[0,1,0] op_sel_hi:[1,1,1]
    v_lshlrev_b32 v32, 16, v111
    v_and_b32 v33, s87, v111
    v_pk_fma_f32 v[20:21], v[32:33], v[8:9], v[20:21] op_sel:[0,1,0] op_sel_hi:[1,1,1]
    v_lshlrev_b32 v26, 16, v112
    v_and_b32 v27, s87, v112
    v_pk_fma_f32 v[14:15], v[26:27], v[10:11], v[14:15] op_sel:[0,0,0] op_sel_hi:[1,0,1]
    v_lshlrev_b32 v28, 16, v113
    v_and_b32 v29, s87, v113
    v_pk_fma_f32 v[16:17], v[28:29], v[10:11], v[16:17] op_sel:[0,0,0] op_sel_hi:[1,0,1]
    v_lshlrev_b32 v30, 16, v114
    v_and_b32 v31, s87, v114
    v_pk_fma_f32 v[18:19], v[30:31], v[10:11], v[18:19] op_sel:[0,0,0] op_sel_hi:[1,0,1]
    v_lshlrev_b32 v32, 16, v115
    v_and_b32 v33, s87, v115
    v_pk_fma_f32 v[20:21], v[32:33], v[10:11], v[20:21] op_sel:[0,0,0] op_sel_hi:[1,0,1]
    s_waitcnt vmcnt(9)
    buffer_load_dwordx4 v[172:175], v1, s[8:11], s26 offen offset:3072 nt
    v_lshlrev_b32 v26, 16, v116
    v_and_b32 v27, s87, v116
    v_pk_fma_f32 v[14:15], v[26:27], v[10:11], v[14:15] op_sel:[0,1,0] op_sel_hi:[1,1,1]
    v_lshlrev_b32 v28, 16, v117
    v_and_b32 v29, s87, v117
    v_pk_fma_f32 v[16:17], v[28:29], v[10:11], v[16:17] op_sel:[0,1,0] op_sel_hi:[1,1,1]
    v_lshlrev_b32 v30, 16, v118
    v_and_b32 v31, s87, v118
    v_pk_fma_f32 v[18:19], v[30:31], v[10:11], v[18:19] op_sel:[0,1,0] op_sel_hi:[1,1,1]
    v_lshlrev_b32 v32, 16, v119
    v_and_b32 v33, s87, v119
    v_pk_fma_f32 v[20:21], v[32:33], v[10:11], v[20:21] op_sel:[0,1,0] op_sel_hi:[1,1,1]
    v_lshlrev_b32 v26, 16, v120
    v_and_b32 v27, s87, v120
    v_pk_fma_f32 v[14:15], v[26:27], v[12:13], v[14:15] op_sel:[0,0,0] op_sel_hi:[1,0,1]
    v_lshlrev_b32 v28, 16, v121
    v_and_b32 v29, s87, v121
    v_pk_fma_f32 v[16:17], v[28:29], v[12:13], v[16:17] op_sel:[0,0,0] op_sel_hi:[1,0,1]
    v_lshlrev_b32 v30, 16, v122
    v_and_b32 v31, s87, v122
    v_pk_fma_f32 v[18:19], v[30:31], v[12:13], v[18:19] op_sel:[0,0,0] op_sel_hi:[1,0,1]
    v_lshlrev_b32 v32, 16, v123
    v_and_b32 v33, s87, v123
    v_pk_fma_f32 v[20:21], v[32:33], v[12:13], v[20:21] op_sel:[0,0,0] op_sel_hi:[1,0,1]
    s_waitcnt vmcnt(9)
    buffer_load_dwordx4 v[176:179], v1, s[8:11], s27 offen offset:0 nt
    v_lshlrev_b32 v26, 16, v124
    v_and_b32 v27, s87, v124
    v_pk_fma_f32 v[14:15], v[26:27], v[12:13], v[14:15] op_sel:[0,1,0] op_sel_hi:[1,1,1]
    v_lshlrev_b32 v28, 16, v125
    v_and_b32 v29, s87, v125
    v_pk_fma_f32 v[16:17], v[28:29], v[12:13], v[16:17] op_sel:[0,1,0] op_sel_hi:[1,1,1]
    v_lshlrev_b32 v30, 16, v126
    v_and_b32 v31, s87, v126
    v_pk_fma_f32 v[18:19], v[30:31], v[12:13], v[18:19] op_sel:[0,1,0] op_sel_hi:[1,1,1]
    v_lshlrev_b32 v32, 16, v127
    v_and_b32 v33, s87, v127
    v_pk_fma_f32 v[20:21], v[32:33], v[12:13], v[20:21] op_sel:[0,1,0] op_sel_hi:[1,1,1]
    v_dot2_f32_bf16 v6, v128, v2, 0
    v_dot2_f32_bf16 v7, v132, v2, 0
    v_dot2_f32_bf16 v6, v129, v3, v6
    v_dot2_f32_bf16 v7, v133, v3, v7
    v_dot2_f32_bf16 v6, v130, v4, v6
    v_dot2_f32_bf16 v7, v134, v4, v7
    v_dot2_f32_bf16 v6, v131, v5, v6
    v_dot2_f32_bf16 v7, v135, v5, v7
    s_waitcnt vmcnt(9)
    buffer_load_dwordx4 v[180:183], v1, s[8:11], s27 offen offset:1024 nt
    v_dot2_f32_bf16 v8, v136, v2, 0
    v_dot2_f32_bf16 v9, v140, v2, 0
    v_dot2_f32_bf16 v8, v137, v3, v8
    v_dot2_f32_bf16 v9, v141, v3, v9
    v_dot2_f32_bf16 v8, v138, v4, v8
    v_dot2_f32_bf16 v9, v142, v4, v9
    v_dot2_f32_bf16 v8, v139, v5, v8
    v_dot2_f32_bf16 v9, v143, v5, v9
    s_waitcnt vmcnt(9)
    buffer_load_dwordx4 v[184:187], v1, s[8:11], s27 offen offset:2048 nt
    s_waitcnt vmcnt(9)
    buffer_load_dwordx4 v[188:191], v1, s[8:11], s27 offen offset:3072 nt
    v_dot2_f32_bf16 v10, v144, v2, 0
    v_dot2_f32_bf16 v11, v148, v2, 0
    v_dot2_f32_bf16 v10, v145, v3, v10
    v_dot2_f32_bf16 v11, v149, v3, v11
    v_dot2_f32_bf16 v10, v146, v4, v10
    v_dot2_f32_bf16 v11, v150, v4, v11
    v_dot2_f32_bf16 v10, v147, v5, v10
    v_dot2_f32_bf16 v11, v151, v5, v11
    s_waitcnt vmcnt(9)
    s_waitcnt vmcnt(8)
    v_dot2_f32_bf16 v12, v152, v2, 0
    v_dot2_f32_bf16 v13, v156, v2, 0
    v_dot2_f32_bf16 v12, v153, v3, v12
    v_dot2_f32_bf16 v13, v157, v3, v13
    v_dot2_f32_bf16 v12, v154, v4, v12
    v_dot2_f32_bf16 v13, v158, v4, v13
    v_dot2_f32_bf16 v12, v155, v5, v12
    v_dot2_f32_bf16 v13, v159, v5, v13
    v_add_f32_dpp v6, v6, v6 row_ror:8 row_mask:0xf bank_mask:0xf
    v_add_f32_dpp v7, v7, v7 row_ror:8 row_mask:0xf bank_mask:0xf
    v_add_f32_dpp v8, v8, v8 row_ror:8 row_mask:0xf bank_mask:0xf
    v_add_f32_dpp v9, v9, v9 row_ror:8 row_mask:0xf bank_mask:0xf
    v_add_f32_dpp v10, v10, v10 row_ror:8 row_mask:0xf bank_mask:0xf
    v_add_f32_dpp v11, v11, v11 row_ror:8 row_mask:0xf bank_mask:0xf
    v_add_f32_dpp v12, v12, v12 row_ror:8 row_mask:0xf bank_mask:0xf
    v_add_f32_dpp v13, v13, v13 row_ror:8 row_mask:0xf bank_mask:0xf
    v_add_f32_dpp v6, v6, v6 row_ror:4 row_mask:0xf bank_mask:0xf
    v_add_f32_dpp v7, v7, v7 row_ror:4 row_mask:0xf bank_mask:0xf
    v_add_f32_dpp v8, v8, v8 row_ror:4 row_mask:0xf bank_mask:0xf
    v_add_f32_dpp v9, v9, v9 row_ror:4 row_mask:0xf bank_mask:0xf
    v_add_f32_dpp v10, v10, v10 row_ror:4 row_mask:0xf bank_mask:0xf
    v_add_f32_dpp v11, v11, v11 row_ror:4 row_mask:0xf bank_mask:0xf
    v_add_f32_dpp v12, v12, v12 row_ror:4 row_mask:0xf bank_mask:0xf
    v_add_f32_dpp v13, v13, v13 row_ror:4 row_mask:0xf bank_mask:0xf
    v_add_f32_dpp v6, v6, v6 row_ror:2 row_mask:0xf bank_mask:0xf
    v_add_f32_dpp v7, v7, v7 row_ror:2 row_mask:0xf bank_mask:0xf
    v_add_f32_dpp v8, v8, v8 row_ror:2 row_mask:0xf bank_mask:0xf
    v_add_f32_dpp v9, v9, v9 row_ror:2 row_mask:0xf bank_mask:0xf
    v_add_f32_dpp v10, v10, v10 row_ror:2 row_mask:0xf bank_mask:0xf
    v_add_f32_dpp v11, v11, v11 row_ror:2 row_mask:0xf bank_mask:0xf
    v_add_f32_dpp v12, v12, v12 row_ror:2 row_mask:0xf bank_mask:0xf
    v_add_f32_dpp v13, v13, v13 row_ror:2 row_mask:0xf bank_mask:0xf
    v_add_f32_dpp v6, v6, v6 row_ror:1 row_mask:0xf bank_mask:0xf
    v_add_f32_dpp v7, v7, v7 row_ror:1 row_mask:0xf bank_mask:0xf
    v_add_f32_dpp v8, v8, v8 row_ror:1 row_mask:0xf bank_mask:0xf
    v_add_f32_dpp v9, v9, v9 row_ror:1 row_mask:0xf bank_mask:0xf
    v_add_f32_dpp v10, v10, v10 row_ror:1 row_mask:0xf bank_mask:0xf
    v_add_f32_dpp v11, v11, v11 row_ror:1 row_mask:0xf bank_mask:0xf
    v_add_f32_dpp v12, v12, v12 row_ror:1 row_mask:0xf bank_mask:0xf
    v_add_f32_dpp v13, v13, v13 row_ror:1 row_mask:0xf bank_mask:0xf
    v_max3_f32 v25, v6, v7, v8
    v_max3_f32 v24, v9, v10, v11
    v_max3_f32 v25, v25, v12, v13
    v_max_f32 v25, v25, v24
    v_mul_f32 v25, s86, v25
    v_max_f32 v25, v25, v22
    v_mov_b32 v24, v25
    s_nop 1
    v_permlane32_swap_b32 v25, v24
    v_max_f32 v25, v25, v24
    v_mov_b32 v24, v25
    s_nop 1
    v_permlane16_swap_b32 v25, v24
    v_max_f32 v25, v25, v24
    v_sub_f32 v24, v22, v25
    v_mov_b32 v22, v25
    v_exp_f32 v24, v24
    v_fma_f32 v6, v6, s86, -v22
    v_fma_f32 v7, v7, s86, -v22
    v_fma_f32 v8, v8, s86, -v22
    v_fma_f32 v9, v9, s86, -v22
    v_fma_f32 v10, v10, s86, -v22
    v_fma_f32 v11, v11, s86, -v22
    v_fma_f32 v12, v12, s86, -v22
    v_fma_f32 v13, v13, s86, -v22
    v_exp_f32 v6, v6
    v_exp_f32 v7, v7
    v_exp_f32 v8, v8
    v_exp_f32 v9, v9
    v_exp_f32 v10, v10
    v_exp_f32 v11, v11
    v_exp_f32 v12, v12
    v_exp_f32 v13, v13
    v_fma_f32 v23, v23, v24, v6
    v_add_f32 v25, v7, v8
    v_add_f32 v26, v9, v10
    v_add_f32 v23, v23, v11
    v_add_f32 v25, v25, v12
    v_add_f32 v26, v26, v13
    v_add_f32 v23, v23, v25
    v_add_f32 v23, v23, v26
    v_mov_b32 v25, v23
    s_nop 1
    v_permlane32_swap_b32 v23, v25
    v_add_f32 v23, v23, v25
    v_mov_b32 v25, v23
    s_nop 1
    v_permlane16_swap_b32 v23, v25
    v_add_f32 v23, v23, v25
    ds_write_b64 v43, v[22:23] offset:9344
    s_waitcnt lgkmcnt(0)
    s_barrier
    v_pk_mul_f32 v[14:15], v[14:15], v[24:25] op_sel:[0,0] op_sel_hi:[1,0]
    v_pk_mul_f32 v[16:17], v[16:17], v[24:25] op_sel:[0,0] op_sel_hi:[1,0]
    v_pk_mul_f32 v[18:19], v[18:19], v[24:25] op_sel:[0,0] op_sel_hi:[1,0]
    v_pk_mul_f32 v[20:21], v[20:21], v[24:25] op_sel:[0,0] op_sel_hi:[1,0]
    s_waitcnt vmcnt(7)
    v_lshlrev_b32 v26, 16, v160
    v_and_b32 v27, s87, v160
    v_pk_fma_f32 v[14:15], v[26:27], v[6:7], v[14:15] op_sel:[0,0,0] op_sel_hi:[1,0,1]
    v_lshlrev_b32 v28, 16, v161
    v_and_b32 v29, s87, v161
    v_pk_fma_f32 v[16:17], v[28:29], v[6:7], v[16:17] op_sel:[0,0,0] op_sel_hi:[1,0,1]
    v_lshlrev_b32 v30, 16, v162
    v_and_b32 v31, s87, v162
    v_pk_fma_f32 v[18:19], v[30:31], v[6:7], v[18:19] op_sel:[0,0,0] op_sel_hi:[1,0,1]
    v_lshlrev_b32 v32, 16, v163
    v_and_b32 v33, s87, v163
    v_pk_fma_f32 v[20:21], v[32:33], v[6:7], v[20:21] op_sel:[0,0,0] op_sel_hi:[1,0,1]
    s_waitcnt vmcnt(6)
    v_lshlrev_b32 v26, 16, v164
    v_and_b32 v27, s87, v164
    v_pk_fma_f32 v[14:15], v[26:27], v[6:7], v[14:15] op_sel:[0,1,0] op_sel_hi:[1,1,1]
    v_lshlrev_b32 v28, 16, v165
    v_and_b32 v29, s87, v165
    v_pk_fma_f32 v[16:17], v[28:29], v[6:7], v[16:17] op_sel:[0,1,0] op_sel_hi:[1,1,1]
    v_lshlrev_b32 v30, 16, v166
    v_and_b32 v31, s87, v166
    v_pk_fma_f32 v[18:19], v[30:31], v[6:7], v[18:19] op_sel:[0,1,0] op_sel_hi:[1,1,1]
    v_lshlrev_b32 v32, 16, v167
    v_and_b32 v33, s87, v167
    v_pk_fma_f32 v[20:21], v[32:33], v[6:7], v[20:21] op_sel:[0,1,0] op_sel_hi:[1,1,1]
    s_waitcnt vmcnt(5)
    v_lshlrev_b32 v26, 16, v168
    v_and_b32 v27, s87, v168
    v_pk_fma_f32 v[14:15], v[26:27], v[8:9], v[14:15] op_sel:[0,0,0] op_sel_hi:[1,0,1]
    v_lshlrev_b32 v28, 16, v169
    v_and_b32 v29, s87, v169
    v_pk_fma_f32 v[16:17], v[28:29], v[8:9], v[16:17] op_sel:[0,0,0] op_sel_hi:[1,0,1]
    v_lshlrev_b32 v30, 16, v170
    v_and_b32 v31, s87, v170
    v_pk_fma_f32 v[18:19], v[30:31], v[8:9], v[18:19] op_sel:[0,0,0] op_sel_hi:[1,0,1]
    v_lshlrev_b32 v32, 16, v171
    v_and_b32 v33, s87, v171
    v_pk_fma_f32 v[20:21], v[32:33], v[8:9], v[20:21] op_sel:[0,0,0] op_sel_hi:[1,0,1]
    s_waitcnt vmcnt(4)
    v_lshlrev_b32 v26, 16, v172
    v_and_b32 v27, s87, v172
    v_pk_fma_f32 v[14:15], v[26:27], v[8:9], v[14:15] op_sel:[0,1,0] op_sel_hi:[1,1,1]
    v_lshlrev_b32 v28, 16, v173
    v_and_b32 v29, s87, v173
    v_pk_fma_f32 v[16:17], v[28:29], v[8:9], v[16:17] op_sel:[0,1,0] op_sel_hi:[1,1,1]
    v_lshlrev_b32 v30, 16, v174
    v_and_b32 v31, s87, v174
    v_pk_fma_f32 v[18:19], v[30:31], v[8:9], v[18:19] op_sel:[0,1,0] op_sel_hi:[1,1,1]
    v_lshlrev_b32 v32, 16, v175
    v_and_b32 v33, s87, v175
    v_pk_fma_f32 v[20:21], v[32:33], v[8:9], v[20:21] op_sel:[0,1,0] op_sel_hi:[1,1,1]
    s_waitcnt vmcnt(3)
    v_lshlrev_b32 v26, 16, v176
    v_and_b32 v27, s87, v176
    v_pk_fma_f32 v[14:15], v[26:27], v[10:11], v[14:15] op_sel:[0,0,0] op_sel_hi:[1,0,1]
    v_lshlrev_b32 v28, 16, v177
    v_and_b32 v29, s87, v177
    v_pk_fma_f32 v[16:17], v[28:29], v[10:11], v[16:17] op_sel:[0,0,0] op_sel_hi:[1,0,1]
    v_lshlrev_b32 v30, 16, v178
    v_and_b32 v31, s87, v178
    v_pk_fma_f32 v[18:19], v[30:31], v[10:11], v[18:19] op_sel:[0,0,0] op_sel_hi:[1,0,1]
    v_lshlrev_b32 v32, 16, v179
    v_and_b32 v33, s87, v179
    v_pk_fma_f32 v[20:21], v[32:33], v[10:11], v[20:21] op_sel:[0,0,0] op_sel_hi:[1,0,1]
    s_waitcnt vmcnt(2)
    v_lshlrev_b32 v26, 16, v180
    v_and_b32 v27, s87, v180
    v_pk_fma_f32 v[14:15], v[26:27], v[10:11], v[14:15] op_sel:[0,1,0] op_sel_hi:[1,1,1]
    v_lshlrev_b32 v28, 16, v181
    v_and_b32 v29, s87, v181
    v_pk_fma_f32 v[16:17], v[28:29], v[10:11], v[16:17] op_sel:[0,1,0] op_sel_hi:[1,1,1]
    v_lshlrev_b32 v30, 16, v182
    v_and_b32 v31, s87, v182
    v_pk_fma_f32 v[18:19], v[30:31], v[10:11], v[18:19] op_sel:[0,1,0] op_sel_hi:[1,1,1]
    v_lshlrev_b32 v32, 16, v183
    v_and_b32 v33, s87, v183
    v_pk_fma_f32 v[20:21], v[32:33], v[10:11], v[20:21] op_sel:[0,1,0] op_sel_hi:[1,1,1]
    s_waitcnt vmcnt(1)
    v_lshlrev_b32 v26, 16, v184
    v_and_b32 v27, s87, v184
    v_pk_fma_f32 v[14:15], v[26:27], v[12:13], v[14:15] op_sel:[0,0,0] op_sel_hi:[1,0,1]
    v_lshlrev_b32 v28, 16, v185
    v_and_b32 v29, s87, v185
    v_pk_fma_f32 v[16:17], v[28:29], v[12:13], v[16:17] op_sel:[0,0,0] op_sel_hi:[1,0,1]
    v_lshlrev_b32 v30, 16, v186
    v_and_b32 v31, s87, v186
    v_pk_fma_f32 v[18:19], v[30:31], v[12:13], v[18:19] op_sel:[0,0,0] op_sel_hi:[1,0,1]
    v_lshlrev_b32 v32, 16, v187
    v_and_b32 v33, s87, v187
    v_pk_fma_f32 v[20:21], v[32:33], v[12:13], v[20:21] op_sel:[0,0,0] op_sel_hi:[1,0,1]
    s_waitcnt vmcnt(0)
    v_lshlrev_b32 v26, 16, v188
    v_and_b32 v27, s87, v188
    v_pk_fma_f32 v[14:15], v[26:27], v[12:13], v[14:15] op_sel:[0,1,0] op_sel_hi:[1,1,1]
    v_lshlrev_b32 v28, 16, v189
    v_and_b32 v29, s87, v189
    v_pk_fma_f32 v[16:17], v[28:29], v[12:13], v[16:17] op_sel:[0,1,0] op_sel_hi:[1,1,1]
    v_lshlrev_b32 v30, 16, v190
    v_and_b32 v31, s87, v190
    v_pk_fma_f32 v[18:19], v[30:31], v[12:13], v[18:19] op_sel:[0,1,0] op_sel_hi:[1,1,1]
    v_lshlrev_b32 v32, 16, v191
    v_and_b32 v33, s87, v191
    v_pk_fma_f32 v[20:21], v[32:33], v[12:13], v[20:21] op_sel:[0,1,0] op_sel_hi:[1,1,1]
    v_permlane32_swap_b32 v14, v18
    v_permlane32_swap_b32 v15, v19
    v_permlane32_swap_b32 v16, v20
    v_permlane32_swap_b32 v17, v21
    v_add_f32 v14, v14, v18
    v_add_f32 v15, v15, v19
    v_add_f32 v16, v16, v20
    v_add_f32 v17, v17, v21
    s_nop 0
    v_permlane16_swap_b32 v14, v16
    v_permlane16_swap_b32 v15, v17
    v_add_f32 v14, v14, v16
    v_add_f32 v15, v15, v17
    ds_write_b64 v42, v[14:15] offset:9408
    s_waitcnt lgkmcnt(0)
    s_barrier
    s_cmp_lg_u32 s3, 0
    s_cbranch_scc1 L_fin
    s_mul_i32 s20, s88, 2304
    s_add_u32 s12, s62, s20
    s_addc_u32 s13, s63, 0
    s_mov_b32 s14, 2304
    s_mov_b32 s15, 0x20000
    v_add_u32 v2, 2048, v1
    s_barrier
    ds_read_b128 v[8:11], v1 offset:11456
    ds_read_b128 v[12:15], v1 offset:11712
    ds_read_b128 v[16:19], v1 offset:11968
    ds_read_b128 v[20:23], v1 offset:12224
    s_waitcnt lgkmcnt(0)
    v_add_f32 v8, v8, v12
    v_add_f32 v16, v16, v20
    v_add_f32 v9, v9, v13
    v_add_f32 v17, v17, v21
    v_add_f32 v10, v10, v14
    v_add_f32 v18, v18, v22
    v_add_f32 v11, v11, v15
    v_add_f32 v19, v19, v23
    v_add_f32 v8, v8, v16
    v_add_f32 v9, v9, v17
    v_add_f32 v10, v10, v18
    v_add_f32 v11, v11, v19
    v_min_u32 v8, -2, v8
    v_min_u32 v9, -2, v9
    v_min_u32 v10, -2, v10
    v_min_u32 v11, -2, v11
    buffer_store_dwordx4 v[8:11], v2, s[12:15], 0 offen sc1
    s_branch L_fin
    s_nop 4
L_helper:
    s_sub_u32 s67, s3, 4
    s_mov_b32 s66, s65
    v_lshrrev_b32 v2, 4, v0
    v_and_b32 v3, 15, v0
    v_mov_b32 v4, 0
    v_mov_b32 v5, 0
    v_mov_b32 v6, 9376
    ds_write_b64 v6, v[4:5]
    v_lshlrev_b32 v6, 2, v0
    s_mov_b32 exec_lo, 0x00ffffff
    s_mov_b32 exec_hi, 0
    ds_write_b32 v6, v4 offset:9248
    s_mov_b64 exec, -1
    s_waitcnt lgkmcnt(0)
    s_mul_i32 s21, s64, 1152
    s_add_u32 s4, s36, s21
    s_addc_u32 s5, s37, 0
    s_mov_b32 s6, 1152
    s_mov_b32 s7, 0x20000
    s_lshl_b32 s20, s65, 8
    s_add_u32 s8, s42, s20
    s_addc_u32 s9, s43, 0
    s_sub_u32 s10, 4718592, s20
    s_mov_b32 s11, 0x20000
    s_mul_i32 s20, s67, 288
    v_mul_u32_u24 v4, 72, v2
    v_add_u32 v4, s20, v4
    buffer_load_dwordx4 v[40:43], v4, s[4:7], 0 offen offset:0
    buffer_load_dwordx4 v[44:47], v4, s[4:7], 0 offen offset:16
    buffer_load_dwordx4 v[48:51], v4, s[4:7], 0 offen offset:32
    buffer_load_dwordx4 v[52:55], v4, s[4:7], 0 offen offset:48
    buffer_load_dwordx2 v[56:57], v4, s[4:7], 0 offen offset:64
    s_mul_i32 s20, s67, 144
    v_mul_u32_u24 v5, 36, v2
    v_add_u32 v5, s20, v5
    v_lshlrev_b32 v5, 13, v5
    v_lshl_add_u32 v5, v3, 4, v5
    s_mov_b32 s20, 0
    buffer_load_dwordx4 v[64:67], v5, s[8:11], s20 offen
    s_add_u32 s20, s20, 0x2000
    buffer_load_dwordx4 v[68:71], v5, s[8:11], s20 offen
    s_add_u32 s20, s20, 0x2000
    buffer_load_dwordx4 v[72:75], v5, s[8:11], s20 offen
    s_add_u32 s20, s20, 0x2000
    buffer_load_dwordx4 v[76:79], v5, s[8:11], s20 offen
    s_add_u32 s20, s20, 0x2000
    buffer_load_dwordx4 v[80:83], v5, s[8:11], s20 offen
    s_add_u32 s20, s20, 0x2000
    buffer_load_dwordx4 v[84:87], v5, s[8:11], s20 offen
    s_add_u32 s20, s20, 0x2000
    buffer_load_dwordx4 v[88:91], v5, s[8:11], s20 offen
    s_add_u32 s20, s20, 0x2000
    buffer_load_dwordx4 v[92:95], v5, s[8:11], s20 offen
    s_add_u32 s20, s20, 0x2000
    v_mov_b32 v16, 0
    v_mov_b32 v17, 0
    v_mov_b32 v18, 0
    v_mov_b32 v19, 0
    v_mov_b32 v20, 0
    v_mov_b32 v21, 0
    v_mov_b32 v22, 0
    v_mov_b32 v23, 0
    s_waitcnt vmcnt(6)
    buffer_load_dwordx4 v[96:99], v5, s[8:11], s20 offen
    s_add_u32 s20, s20, 0x2000
    buffer_load_dwordx4 v[100:103], v5, s[8:11], s20 offen
    s_add_u32 s20, s20, 0x2000
    v_perm_b32 v32, v68, v64, s84
    v_perm_b32 v33, v68, v64, s85
    v_perm_b32 v34, v69, v65, s84
    v_perm_b32 v35, v69, v65, s85
    v_dot2c_f32_bf16 v16, v40, v32
    v_dot2c_f32_bf16 v17, v40, v33
    v_dot2c_f32_bf16 v18, v40, v34
    v_dot2c_f32_bf16 v19, v40, v35
    v_perm_b32 v36, v70, v66, s84
    v_perm_b32 v37, v70, v66, s85
    v_perm_b32 v38, v71, v67, s84
    v_perm_b32 v39, v71, v67, s85
    v_dot2c_f32_bf16 v20, v40, v36
    v_dot2c_f32_bf16 v21, v40, v37
    v_dot2c_f32_bf16 v22, v40, v38
    v_dot2c_f32_bf16 v23, v40, v39
    s_waitcnt vmcnt(6)
    buffer_load_dwordx4 v[104:107], v5, s[8:11], s20 offen
    s_add_u32 s20, s20, 0x2000
    buffer_load_dwordx4 v[108:111], v5, s[8:11], s20 offen
    s_add_u32 s20, s20, 0x2000
    v_perm_b32 v32, v76, v72, s84
    v_perm_b32 v33, v76, v72, s85
    v_perm_b32 v34, v77, v73, s84
    v_perm_b32 v35, v77, v73, s85
    v_dot2c_f32_bf16 v16, v41, v32
    v_dot2c_f32_bf16 v17, v41, v33
    v_dot2c_f32_bf16 v18, v41, v34
    v_dot2c_f32_bf16 v19, v41, v35
    v_perm_b32 v36, v78, v74, s84
    v_perm_b32 v37, v78, v74, s85
    v_perm_b32 v38, v79, v75, s84
    v_perm_b32 v39, v79, v75, s85
    v_dot2c_f32_bf16 v20, v41, v36
    v_dot2c_f32_bf16 v21, v41, v37
    v_dot2c_f32_bf16 v22, v41, v38
    v_dot2c_f32_bf16 v23, v41, v39
    s_waitcnt vmcnt(6)
    buffer_load_dwordx4 v[112:115], v5, s[8:11], s20 offen
    s_add_u32 s20, s20, 0x2000
    buffer_load_dwordx4 v[116:119], v5, s[8:11], s20 offen
    s_add_u32 s20, s20, 0x2000
    v_perm_b32 v32, v84, v80, s84
    v_perm_b32 v33, v84, v80, s85
    v_perm_b32 v34, v85, v81, s84
    v_perm_b32 v35, v85, v81, s85
    v_dot2c_f32_bf16 v16, v42, v32
    v_dot2c_f32_bf16 v17, v42, v33
    v_dot2c_f32_bf16 v18, v42, v34
    v_dot2c_f32_bf16 v19, v42, v35
    v_perm_b32 v36, v86, v82, s84
    v_perm_b32 v37, v86, v82, s85
    v_perm_b32 v38, v87, v83, s84
    v_perm_b32 v39, v87, v83, s85
    v_dot2c_f32_bf16 v20, v42, v36
    v_dot2c_f32_bf16 v21, v42, v37
    v_dot2c_f32_bf16 v22, v42, v38
    v_dot2c_f32_bf16 v23, v42, v39
    s_waitcnt vmcnt(6)
    buffer_load_dwordx4 v[120:123], v5, s[8:11], s20 offen
    s_add_u32 s20, s20, 0x2000
    buffer_load_dwordx4 v[124:127], v5, s[8:11], s20 offen
    s_add_u32 s20, s20, 0x2000
    v_perm_b32 v32, v92, v88, s84
    v_perm_b32 v33, v92, v88, s85
    v_perm_b32 v34, v93, v89, s84
    v_perm_b32 v35, v93, v89, s85
    v_dot2c_f32_bf16 v16, v43, v32
    v_dot2c_f32_bf16 v17, v43, v33
    v_dot2c_f32_bf16 v18, v43, v34
    v_dot2c_f32_bf16 v19, v43, v35
    v_perm_b32 v36, v94, v90, s84
    v_perm_b32 v37, v94, v90, s85
    v_perm_b32 v38, v95, v91, s84
    v_perm_b32 v39, v95, v91, s85
    v_dot2c_f32_bf16 v20, v43, v36
    v_dot2c_f32_bf16 v21, v43, v37
    v_dot2c_f32_bf16 v22, v43, v38
    v_dot2c_f32_bf16 v23, v43, v39
    s_waitcnt vmcnt(6)
    buffer_load_dwordx4 v[128:131], v5, s[8:11], s20 offen
    s_add_u32 s20, s20, 0x2000
    buffer_load_dwordx4 v[132:135], v5, s[8:11], s20 offen
    s_add_u32 s20, s20, 0x2000
    v_perm_b32 v32, v100, v96, s84
    v_perm_b32 v33, v100, v96, s85
    v_perm_b32 v34, v101, v97, s84
    v_perm_b32 v35, v101, v97, s85
    v_dot2c_f32_bf16 v16, v44, v32
    v_dot2c_f32_bf16 v17, v44, v33
    v_dot2c_f32_bf16 v18, v44, v34
    v_dot2c_f32_bf16 v19, v44, v35
    v_perm_b32 v36, v102, v98, s84
    v_perm_b32 v37, v102, v98, s85
    v_perm_b32 v38, v103, v99, s84
    v_perm_b32 v39, v103, v99, s85
    v_dot2c_f32_bf16 v20, v44, v36
    v_dot2c_f32_bf16 v21, v44, v37
    v_dot2c_f32_bf16 v22, v44, v38
    v_dot2c_f32_bf16 v23, v44, v39
    s_waitcnt vmcnt(6)
    buffer_load_dwordx4 v[136:139], v5, s[8:11], s20 offen
    s_add_u32 s20, s20, 0x2000
    buffer_load_dwordx4 v[140:143], v5, s[8:11], s20 offen
    s_add_u32 s20, s20, 0x2000
    v_perm_b32 v32, v108, v104, s84
    v_perm_b32 v33, v108, v104, s85
    v_perm_b32 v34, v109, v105, s84
    v_perm_b32 v35, v109, v105, s85
    v_dot2c_f32_bf16 v16, v45, v32
    v_dot2c_f32_bf16 v17, v45, v33
    v_dot2c_f32_bf16 v18, v45, v34
    v_dot2c_f32_bf16 v19, v45, v35
    v_perm_b32 v36, v110, v106, s84
    v_perm_b32 v37, v110, v106, s85
    v_perm_b32 v38, v111, v107, s84
    v_perm_b32 v39, v111, v107, s85
    v_dot2c_f32_bf16 v20, v45, v36
    v_dot2c_f32_bf16 v21, v45, v37
    v_dot2c_f32_bf16 v22, v45, v38
    v_dot2c_f32_bf16 v23, v45, v39
    s_waitcnt vmcnt(6)
    buffer_load_dwordx4 v[144:147], v5, s[8:11], s20 offen
    s_add_u32 s20, s20, 0x2000
    buffer_load_dwordx4 v[148:151], v5, s[8:11], s20 offen
    s_add_u32 s20, s20, 0x2000
    v_perm_b32 v32, v116, v112, s84
    v_perm_b32 v33, v116, v112, s85
    v_perm_b32 v34, v117, v113, s84
    v_perm_b32 v35, v117, v113, s85
    v_dot2c_f32_bf16 v16, v46, v32
    v_dot2c_f32_bf16 v17, v46, v33
    v_dot2c_f32_bf16 v18, v46, v34
    v_dot2c_f32_bf16 v19, v46, v35
    v_perm_b32 v36, v118, v114, s84
    v_perm_b32 v37, v118, v114, s85
    v_perm_b32 v38, v119, v115, s84
    v_perm_b32 v39, v119, v115, s85
    v_dot2c_f32_bf16 v20, v46, v36
    v_dot2c_f32_bf16 v21, v46, v37
    v_dot2c_f32_bf16 v22, v46, v38
    v_dot2c_f32_bf16 v23, v46, v39
    s_waitcnt vmcnt(6)
    buffer_load_dwordx4 v[152:155], v5, s[8:11], s20 offen
    s_add_u32 s20, s20, 0x2000
    buffer_load_dwordx4 v[156:159], v5, s[8:11], s20 offen
    s_add_u32 s20, s20, 0x2000
    v_perm_b32 v32, v124, v120, s84
    v_perm_b32 v33, v124, v120, s85
    v_perm_b32 v34, v125, v121, s84
    v_perm_b32 v35, v125, v121, s85
    v_dot2c_f32_bf16 v16, v47, v32
    v_dot2c_f32_bf16 v17, v47, v33
    v_dot2c_f32_bf16 v18, v47, v34
    v_dot2c_f32_bf16 v19, v47, v35
    v_perm_b32 v36, v126, v122, s84
    v_perm_b32 v37, v126, v122, s85
    v_perm_b32 v38, v127, v123, s84
    v_perm_b32 v39, v127, v123, s85
    v_dot2c_f32_bf16 v20, v47, v36
    v_dot2c_f32_bf16 v21, v47, v37
    v_dot2c_f32_bf16 v22, v47, v38
    v_dot2c_f32_bf16 v23, v47, v39
    s_waitcnt vmcnt(6)
    buffer_load_dwordx4 v[160:163], v5, s[8:11], s20 offen
    s_add_u32 s20, s20, 0x2000
    buffer_load_dwordx4 v[164:167], v5, s[8:11], s20 offen
    s_add_u32 s20, s20, 0x2000
    v_perm_b32 v32, v132, v128, s84
    v_perm_b32 v33, v132, v128, s85
    v_perm_b32 v34, v133, v129, s84
    v_perm_b32 v35, v133, v129, s85
    v_dot2c_f32_bf16 v16, v48, v32
    v_dot2c_f32_bf16 v17, v48, v33
    v_dot2c_f32_bf16 v18, v48, v34
    v_dot2c_f32_bf16 v19, v48, v35
    v_perm_b32 v36, v134, v130, s84
    v_perm_b32 v37, v134, v130, s85
    v_perm_b32 v38, v135, v131, s84
    v_perm_b32 v39, v135, v131, s85
    v_dot2c_f32_bf16 v20, v48, v36
    v_dot2c_f32_bf16 v21, v48, v37
    v_dot2c_f32_bf16 v22, v48, v38
    v_dot2c_f32_bf16 v23, v48, v39
    s_waitcnt vmcnt(6)
    buffer_load_dwordx4 v[168:171], v5, s[8:11], s20 offen
    s_add_u32 s20, s20, 0x2000
    buffer_load_dwordx4 v[172:175], v5, s[8:11], s20 offen
    s_add_u32 s20, s20, 0x2000
    v_perm_b32 v32, v140, v136, s84
    v_perm_b32 v33, v140, v136, s85
    v_perm_b32 v34, v141, v137, s84
    v_perm_b32 v35, v141, v137, s85
    v_dot2c_f32_bf16 v16, v49, v32
    v_dot2c_f32_bf16 v17, v49, v33
    v_dot2c_f32_bf16 v18, v49, v34
    v_dot2c_f32_bf16 v19, v49, v35
    v_perm_b32 v36, v142, v138, s84
    v_perm_b32 v37, v142, v138, s85
    v_perm_b32 v38, v143, v139, s84
    v_perm_b32 v39, v143, v139, s85
    v_dot2c_f32_bf16 v20, v49, v36
    v_dot2c_f32_bf16 v21, v49, v37
    v_dot2c_f32_bf16 v22, v49, v38
    v_dot2c_f32_bf16 v23, v49, v39
    s_waitcnt vmcnt(6)
    buffer_load_dwordx4 v[176:179], v5, s[8:11], s20 offen
    s_add_u32 s20, s20, 0x2000
    buffer_load_dwordx4 v[180:183], v5, s[8:11], s20 offen
    s_add_u32 s20, s20, 0x2000
    v_perm_b32 v32, v148, v144, s84
    v_perm_b32 v33, v148, v144, s85
    v_perm_b32 v34, v149, v145, s84
    v_perm_b32 v35, v149, v145, s85
    v_dot2c_f32_bf16 v16, v50, v32
    v_dot2c_f32_bf16 v17, v50, v33
    v_dot2c_f32_bf16 v18, v50, v34
    v_dot2c_f32_bf16 v19, v50, v35
    v_perm_b32 v36, v150, v146, s84
    v_perm_b32 v37, v150, v146, s85
    v_perm_b32 v38, v151, v147, s84
    v_perm_b32 v39, v151, v147, s85
    v_dot2c_f32_bf16 v20, v50, v36
    v_dot2c_f32_bf16 v21, v50, v37
    v_dot2c_f32_bf16 v22, v50, v38
    v_dot2c_f32_bf16 v23, v50, v39
    s_waitcnt vmcnt(6)
    buffer_load_dwordx4 v[184:187], v5, s[8:11], s20 offen
    s_add_u32 s20, s20, 0x2000
    buffer_load_dwordx4 v[188:191], v5, s[8:11], s20 offen
    s_add_u32 s20, s20, 0x2000
    v_perm_b32 v32, v156, v152, s84
    v_perm_b32 v33, v156, v152, s85
    v_perm_b32 v34, v157, v153, s84
    v_perm_b32 v35, v157, v153, s85
    v_dot2c_f32_bf16 v16, v51, v32
    v_dot2c_f32_bf16 v17, v51, v33
    v_dot2c_f32_bf16 v18, v51, v34
    v_dot2c_f32_bf16 v19, v51, v35
    v_perm_b32 v36, v158, v154, s84
    v_perm_b32 v37, v158, v154, s85
    v_perm_b32 v38, v159, v155, s84
    v_perm_b32 v39, v159, v155, s85
    v_dot2c_f32_bf16 v20, v51, v36
    v_dot2c_f32_bf16 v21, v51, v37
    v_dot2c_f32_bf16 v22, v51, v38
    v_dot2c_f32_bf16 v23, v51, v39
    s_waitcnt vmcnt(6)
    buffer_load_dwordx4 v[192:195], v5, s[8:11], s20 offen
    s_add_u32 s20, s20, 0x2000
    buffer_load_dwordx4 v[196:199], v5, s[8:11], s20 offen
    s_add_u32 s20, s20, 0x2000
    v_perm_b32 v32, v164, v160, s84
    v_perm_b32 v33, v164, v160, s85
    v_perm_b32 v34, v165, v161, s84
    v_perm_b32 v35, v165, v161, s85
    v_dot2c_f32_bf16 v16, v52, v32
    v_dot2c_f32_bf16 v17, v52, v33
    v_dot2c_f32_bf16 v18, v52, v34
    v_dot2c_f32_bf16 v19, v52, v35
    v_perm_b32 v36, v166, v162, s84
    v_perm_b32 v37, v166, v162, s85
    v_perm_b32 v38, v167, v163, s84
    v_perm_b32 v39, v167, v163, s85
    v_dot2c_f32_bf16 v20, v52, v36
    v_dot2c_f32_bf16 v21, v52, v37
    v_dot2c_f32_bf16 v22, v52, v38
    v_dot2c_f32_bf16 v23, v52, v39
    s_waitcnt vmcnt(6)
    buffer_load_dwordx4 v[200:203], v5, s[8:11], s20 offen
    s_add_u32 s20, s20, 0x2000
    buffer_load_dwordx4 v[204:207], v5, s[8:11], s20 offen
    v_perm_b32 v32, v172, v168, s84
    v_perm_b32 v33, v172, v168, s85
    v_perm_b32 v34, v173, v169, s84
    v_perm_b32 v35, v173, v169, s85
    v_dot2c_f32_bf16 v16, v53, v32
    v_dot2c_f32_bf16 v17, v53, v33
    v_dot2c_f32_bf16 v18, v53, v34
    v_dot2c_f32_bf16 v19, v53, v35
    v_perm_b32 v36, v174, v170, s84
    v_perm_b32 v37, v174, v170, s85
    v_perm_b32 v38, v175, v171, s84
    v_perm_b32 v39, v175, v171, s85
    v_dot2c_f32_bf16 v20, v53, v36
    v_dot2c_f32_bf16 v21, v53, v37
    v_dot2c_f32_bf16 v22, v53, v38
    v_dot2c_f32_bf16 v23, v53, v39
    s_waitcnt vmcnt(6)
    v_perm_b32 v32, v180, v176, s84
    v_perm_b32 v33, v180, v176, s85
    v_perm_b32 v34, v181, v177, s84
    v_perm_b32 v35, v181, v177, s85
    v_dot2c_f32_bf16 v16, v54, v32
    v_dot2c_f32_bf16 v17, v54, v33
    v_dot2c_f32_bf16 v18, v54, v34
    v_dot2c_f32_bf16 v19, v54, v35
    v_perm_b32 v36, v182, v178, s84
    v_perm_b32 v37, v182, v178, s85
    v_perm_b32 v38, v183, v179, s84
    v_perm_b32 v39, v183, v179, s85
    v_dot2c_f32_bf16 v20, v54, v36
    v_dot2c_f32_bf16 v21, v54, v37
    v_dot2c_f32_bf16 v22, v54, v38
    v_dot2c_f32_bf16 v23, v54, v39
    s_waitcnt vmcnt(4)
    v_perm_b32 v32, v188, v184, s84
    v_perm_b32 v33, v188, v184, s85
    v_perm_b32 v34, v189, v185, s84
    v_perm_b32 v35, v189, v185, s85
    v_dot2c_f32_bf16 v16, v55, v32
    v_dot2c_f32_bf16 v17, v55, v33
    v_dot2c_f32_bf16 v18, v55, v34
    v_dot2c_f32_bf16 v19, v55, v35
    v_perm_b32 v36, v190, v186, s84
    v_perm_b32 v37, v190, v186, s85
    v_perm_b32 v38, v191, v187, s84
    v_perm_b32 v39, v191, v187, s85
    v_dot2c_f32_bf16 v20, v55, v36
    v_dot2c_f32_bf16 v21, v55, v37
    v_dot2c_f32_bf16 v22, v55, v38
    v_dot2c_f32_bf16 v23, v55, v39
    s_waitcnt vmcnt(2)
    v_perm_b32 v32, v196, v192, s84
    v_perm_b32 v33, v196, v192, s85
    v_perm_b32 v34, v197, v193, s84
    v_perm_b32 v35, v197, v193, s85
    v_dot2c_f32_bf16 v16, v56, v32
    v_dot2c_f32_bf16 v17, v56, v33
    v_dot2c_f32_bf16 v18, v56, v34
    v_dot2c_f32_bf16 v19, v56, v35
    v_perm_b32 v36, v198, v194, s84
    v_perm_b32 v37, v198, v194, s85
    v_perm_b32 v38, v199, v195, s84
    v_perm_b32 v39, v199, v195, s85
    v_dot2c_f32_bf16 v20, v56, v36
    v_dot2c_f32_bf16 v21, v56, v37
    v_dot2c_f32_bf16 v22, v56, v38
    v_dot2c_f32_bf16 v23, v56, v39
    s_waitcnt vmcnt(0)
    v_perm_b32 v32, v204, v200, s84
    v_perm_b32 v33, v204, v200, s85
    v_perm_b32 v34, v205, v201, s84
    v_perm_b32 v35, v205, v201, s85
    v_dot2c_f32_bf16 v16, v57, v32
    v_dot2c_f32_bf16 v17, v57, v33
    v_dot2c_f32_bf16 v18, v57, v34
    v_dot2c_f32_bf16 v19, v57, v35
    v_perm_b32 v36, v206, v202, s84
    v_perm_b32 v37, v206, v202, s85
    v_perm_b32 v38, v207, v203, s84
    v_perm_b32 v39, v207, v203, s85
    v_dot2c_f32_bf16 v20, v57, v36
    v_dot2c_f32_bf16 v21, v57, v37
    v_dot2c_f32_bf16 v22, v57, v38
    v_dot2c_f32_bf16 v23, v57, v39
    v_permlane32_swap_b32 v16, v20
    v_permlane32_swap_b32 v17, v21
    v_permlane32_swap_b32 v18, v22
    v_permlane32_swap_b32 v19, v23
    v_add_f32 v16, v16, v20
    v_add_f32 v17, v17, v21
    v_add_f32 v18, v18, v22
    v_add_f32 v19, v19, v23
    s_nop 0
    v_permlane16_swap_b32 v16, v18
    v_permlane16_swap_b32 v17, v19
    v_add_f32 v16, v16, v18
    v_add_f32 v17, v17, v19
    v_lshlrev_b32 v6, 5, v3
    v_lshl_add_u32 v6, v2, 3, v6
    s_lshl_b32 s20, s67, 9
    v_add_u32 v6, s20, v6
    ds_write_b64 v6, v[16:17] offset:0
    s_waitcnt lgkmcnt(0)
    s_barrier
    s_mul_i32 s20, s88, 2304
    s_mul_i32 s22, s67, 576
    s_add_u32 s20, s20, s22
    s_add_u32 s12, s62, s20
    s_addc_u32 s13, s63, 0
    s_mov_b32 s14, 576
    s_mov_b32 s15, 0x20000
    v_lshlrev_b32 v1, 4, v0
    v_mov_b32 v32, -1
    v_mov_b32 v33, -1
    v_mov_b32 v34, -1
    v_mov_b32 v35, -1
    buffer_store_dwordx4 v[32:35], v1, s[12:15], 0 offen sc1
    s_lshl_b32 s20, s64, 5
    s_add_u32 s28, s60, s20
    s_addc_u32 s29, s61, 0
    s_mov_b32 s30, 4
    s_mov_b32 s31, 0x20000
    s_mov_b32 s16, s56
    s_mov_b32 s17, s57
    s_mov_b32 s18, 1152
    s_mov_b32 s19, 0x20000
    v_lshlrev_b32 v4, 1, v0
    buffer_load_ushort v64, v4, s[4:7], 0 offen offset:0
    buffer_load_ushort v65, v4, s[4:7], 0 offen offset:128
    buffer_load_ushort v66, v4, s[4:7], 0 offen offset:256
    buffer_load_ushort v67, v4, s[4:7], 0 offen offset:384
    buffer_load_ushort v68, v4, s[4:7], 0 offen offset:512
    buffer_load_ushort v69, v4, s[4:7], 0 offen offset:640
    buffer_load_ushort v70, v4, s[4:7], 0 offen offset:768
    buffer_load_ushort v71, v4, s[4:7], 0 offen offset:896
    buffer_load_ushort v72, v4, s[4:7], 0 offen offset:1024
    buffer_load_ushort v82, v4, s[16:19], 0 offen offset:0
    buffer_load_ushort v83, v4, s[16:19], 0 offen offset:128
    buffer_load_ushort v84, v4, s[16:19], 0 offen offset:256
    buffer_load_ushort v85, v4, s[16:19], 0 offen offset:384
    buffer_load_ushort v86, v4, s[16:19], 0 offen offset:512
    buffer_load_ushort v87, v4, s[16:19], 0 offen offset:640
    buffer_load_ushort v88, v4, s[16:19], 0 offen offset:768
    buffer_load_ushort v89, v4, s[16:19], 0 offen offset:896
    buffer_load_ushort v90, v4, s[16:19], 0 offen offset:1024
    v_mul_u32_u24 v7, 57, v0
    v_lshrrev_b32 v7, 10, v7
    v_mul_u32_u24 v8, 18, v7
    v_sub_u32 v8, v0, v8
    s_mul_i32 s20, s67, 288
    v_mul_u32_u24 v9, 96, v7
    v_add_u32 v9, s20, v9
    buffer_load_dwordx4 v[40:43], v9, s[4:7], 0 offen offset:0
    buffer_load_dwordx4 v[44:47], v9, s[4:7], 0 offen offset:16
    buffer_load_dwordx4 v[48:51], v9, s[4:7], 0 offen offset:32
    buffer_load_dwordx4 v[52:55], v9, s[4:7], 0 offen offset:48
    buffer_load_dwordx4 v[56:59], v9, s[4:7], 0 offen offset:64
    buffer_load_dwordx4 v[60:63], v9, s[4:7], 0 offen offset:80
    s_waitcnt vmcnt(6)
    v_lshlrev_b32 v64, 16, v64
    v_lshlrev_b32 v65, 16, v65
    v_lshlrev_b32 v66, 16, v66
    v_lshlrev_b32 v67, 16, v67
    v_lshlrev_b32 v68, 16, v68
    v_lshlrev_b32 v69, 16, v69
    v_lshlrev_b32 v70, 16, v70
    v_lshlrev_b32 v71, 16, v71
    v_lshlrev_b32 v72, 16, v72
    v_lshlrev_b32 v82, 16, v82
    v_lshlrev_b32 v83, 16, v83
    v_lshlrev_b32 v84, 16, v84
    v_lshlrev_b32 v85, 16, v85
    v_lshlrev_b32 v86, 16, v86
    v_lshlrev_b32 v87, 16, v87
    v_lshlrev_b32 v88, 16, v88
    v_lshlrev_b32 v89, 16, v89
    v_lshlrev_b32 v90, 16, v90
    v_add_f32 v10, v64, v65
    v_add_f32 v10, v10, v66
    v_add_f32 v10, v10, v67
    v_add_f32 v10, v10, v68
    v_add_f32 v10, v10, v69
    v_add_f32 v10, v10, v70
    v_add_f32 v10, v10, v71
    v_add_f32 v10, v10, v72
    v_mul_f32 v12, v64, v82
    v_fmac_f32 v12, v65, v83
    v_fmac_f32 v12, v66, v84
    v_fmac_f32 v12, v67, v85
    v_fmac_f32 v12, v68, v86
    v_fmac_f32 v12, v69, v87
    v_fmac_f32 v12, v70, v88
    v_fmac_f32 v12, v71, v89
    v_fmac_f32 v12, v72, v90
    v_add_f32_dpp v10, v10, v10 row_ror:8 row_mask:0xf bank_mask:0xf
    s_nop 1
    v_add_f32_dpp v10, v10, v10 row_ror:4 row_mask:0xf bank_mask:0xf
    s_nop 1
    v_add_f32_dpp v10, v10, v10 row_ror:2 row_mask:0xf bank_mask:0xf
    s_nop 1
    v_add_f32_dpp v10, v10, v10 row_ror:1 row_mask:0xf bank_mask:0xf
    v_mov_b32 v14, v10
    s_nop 1
    v_permlane16_swap_b32 v10, v14
    v_add_f32 v10, v10, v14
    v_mov_b32 v14, v10
    s_nop 1
    v_permlane32_swap_b32 v10, v14
    v_add_f32 v10, v10, v14
    v_add_f32_dpp v12, v12, v12 row_ror:8 row_mask:0xf bank_mask:0xf
    s_nop 1
    v_add_f32_dpp v12, v12, v12 row_ror:4 row_mask:0xf bank_mask:0xf
    s_nop 1
    v_add_f32_dpp v12, v12, v12 row_ror:2 row_mask:0xf bank_mask:0xf
    s_nop 1
    v_add_f32_dpp v12, v12, v12 row_ror:1 row_mask:0xf bank_mask:0xf
    v_mov_b32 v14, v12
    s_nop 1
    v_permlane16_swap_b32 v12, v14
    v_add_f32 v12, v12, v14
    v_mov_b32 v14, v12
    s_nop 1
    v_permlane32_swap_b32 v12, v14
    v_add_f32 v12, v12, v14
    v_mul_f32 v10, 0x3ae38e39, v10
    v_sub_f32 v64, v64, v10
    v_sub_f32 v65, v65, v10
    v_sub_f32 v66, v66, v10
    v_sub_f32 v67, v67, v10
    v_sub_f32 v68, v68, v10
    v_sub_f32 v69, v69, v10
    v_sub_f32 v70, v70, v10
    v_sub_f32 v71, v71, v10
    v_sub_f32 v72, v72, v10
    v_mul_f32 v11, v64, v64
    v_fmac_f32 v11, v65, v65
    v_fmac_f32 v11, v66, v66
    v_fmac_f32 v11, v67, v67
    v_fmac_f32 v11, v68, v68
    v_fmac_f32 v11, v69, v69
    v_fmac_f32 v11, v70, v70
    v_fmac_f32 v11, v71, v71
    v_fmac_f32 v11, v72, v72
    s_nop 1
    v_add_f32_dpp v11, v11, v11 row_ror:8 row_mask:0xf bank_mask:0xf
    s_nop 1
    v_add_f32_dpp v11, v11, v11 row_ror:4 row_mask:0xf bank_mask:0xf
    s_nop 1
    v_add_f32_dpp v11, v11, v11 row_ror:2 row_mask:0xf bank_mask:0xf
    s_nop 1
    v_add_f32_dpp v11, v11, v11 row_ror:1 row_mask:0xf bank_mask:0xf
    v_mov_b32 v14, v11
    s_nop 1
    v_permlane16_swap_b32 v11, v14
    v_add_f32 v11, v11, v14
    v_mov_b32 v14, v11
    s_nop 1
    v_permlane32_swap_b32 v11, v14
    v_add_f32 v11, v11, v14
    v_mul_f32 v11, 0x3ae38e39, v11
    v_add_f32 v11, 0x3727c5ac, v11
    v_rsq_f32 v11, v11
    v_mul_f32 v12, 0xbfb8aa3b, v12
    v_exp_f32 v12, v12
    s_nop 0
    v_add_f32 v12, 1.0, v12
    v_rcp_f32 v12, v12
    s_nop 0
    v_sub_f32 v13, 1.0, v12
    s_waitcnt vmcnt(0)
    v_lshlrev_b32 v32, 16, v40
    v_and_b32 v33, s87, v40
    v_sub_f32 v32, v32, v10
    v_sub_f32 v33, v33, v10
    v_mul_f32 v32, v32, v11
    v_mul_f32 v33, v33, v11
    v_cvt_pk_bf16_f32 v40, v32, v33
    v_lshlrev_b32 v32, 16, v41
    v_and_b32 v33, s87, v41
    v_sub_f32 v32, v32, v10
    v_sub_f32 v33, v33, v10
    v_mul_f32 v32, v32, v11
    v_mul_f32 v33, v33, v11
    v_cvt_pk_bf16_f32 v41, v32, v33
    v_lshlrev_b32 v32, 16, v42
    v_and_b32 v33, s87, v42
    v_sub_f32 v32, v32, v10
    v_sub_f32 v33, v33, v10
    v_mul_f32 v32, v32, v11
    v_mul_f32 v33, v33, v11
    v_cvt_pk_bf16_f32 v42, v32, v33
    v_lshlrev_b32 v32, 16, v43
    v_and_b32 v33, s87, v43
    v_sub_f32 v32, v32, v10
    v_sub_f32 v33, v33, v10
    v_mul_f32 v32, v32, v11
    v_mul_f32 v33, v33, v11
    v_cvt_pk_bf16_f32 v43, v32, v33
    v_lshlrev_b32 v32, 16, v44
    v_and_b32 v33, s87, v44
    v_sub_f32 v32, v32, v10
    v_sub_f32 v33, v33, v10
    v_mul_f32 v32, v32, v11
    v_mul_f32 v33, v33, v11
    v_cvt_pk_bf16_f32 v44, v32, v33
    v_lshlrev_b32 v32, 16, v45
    v_and_b32 v33, s87, v45
    v_sub_f32 v32, v32, v10
    v_sub_f32 v33, v33, v10
    v_mul_f32 v32, v32, v11
    v_mul_f32 v33, v33, v11
    v_cvt_pk_bf16_f32 v45, v32, v33
    v_lshlrev_b32 v32, 16, v46
    v_and_b32 v33, s87, v46
    v_sub_f32 v32, v32, v10
    v_sub_f32 v33, v33, v10
    v_mul_f32 v32, v32, v11
    v_mul_f32 v33, v33, v11
    v_cvt_pk_bf16_f32 v46, v32, v33
    v_lshlrev_b32 v32, 16, v47
    v_and_b32 v33, s87, v47
    v_sub_f32 v32, v32, v10
    v_sub_f32 v33, v33, v10
    v_mul_f32 v32, v32, v11
    v_mul_f32 v33, v33, v11
    v_cvt_pk_bf16_f32 v47, v32, v33
    v_lshlrev_b32 v32, 16, v48
    v_and_b32 v33, s87, v48
    v_sub_f32 v32, v32, v10
    v_sub_f32 v33, v33, v10
    v_mul_f32 v32, v32, v11
    v_mul_f32 v33, v33, v11
    v_cvt_pk_bf16_f32 v48, v32, v33
    v_lshlrev_b32 v32, 16, v49
    v_and_b32 v33, s87, v49
    v_sub_f32 v32, v32, v10
    v_sub_f32 v33, v33, v10
    v_mul_f32 v32, v32, v11
    v_mul_f32 v33, v33, v11
    v_cvt_pk_bf16_f32 v49, v32, v33
    v_lshlrev_b32 v32, 16, v50
    v_and_b32 v33, s87, v50
    v_sub_f32 v32, v32, v10
    v_sub_f32 v33, v33, v10
    v_mul_f32 v32, v32, v11
    v_mul_f32 v33, v33, v11
    v_cvt_pk_bf16_f32 v50, v32, v33
    v_lshlrev_b32 v32, 16, v51
    v_and_b32 v33, s87, v51
    v_sub_f32 v32, v32, v10
    v_sub_f32 v33, v33, v10
    v_mul_f32 v32, v32, v11
    v_mul_f32 v33, v33, v11
    v_cvt_pk_bf16_f32 v51, v32, v33
    v_lshlrev_b32 v32, 16, v52
    v_and_b32 v33, s87, v52
    v_sub_f32 v32, v32, v10
    v_sub_f32 v33, v33, v10
    v_mul_f32 v32, v32, v11
    v_mul_f32 v33, v33, v11
    v_cvt_pk_bf16_f32 v52, v32, v33
    v_lshlrev_b32 v32, 16, v53
    v_and_b32 v33, s87, v53
    v_sub_f32 v32, v32, v10
    v_sub_f32 v33, v33, v10
    v_mul_f32 v32, v32, v11
    v_mul_f32 v33, v33, v11
    v_cvt_pk_bf16_f32 v53, v32, v33
    v_lshlrev_b32 v32, 16, v54
    v_and_b32 v33, s87, v54
    v_sub_f32 v32, v32, v10
    v_sub_f32 v33, v33, v10
    v_mul_f32 v32, v32, v11
    v_mul_f32 v33, v33, v11
    v_cvt_pk_bf16_f32 v54, v32, v33
    v_lshlrev_b32 v32, 16, v55
    v_and_b32 v33, s87, v55
    v_sub_f32 v32, v32, v10
    v_sub_f32 v33, v33, v10
    v_mul_f32 v32, v32, v11
    v_mul_f32 v33, v33, v11
    v_cvt_pk_bf16_f32 v55, v32, v33
    v_lshlrev_b32 v32, 16, v56
    v_and_b32 v33, s87, v56
    v_sub_f32 v32, v32, v10
    v_sub_f32 v33, v33, v10
    v_mul_f32 v32, v32, v11
    v_mul_f32 v33, v33, v11
    v_cvt_pk_bf16_f32 v56, v32, v33
    v_lshlrev_b32 v32, 16, v57
    v_and_b32 v33, s87, v57
    v_sub_f32 v32, v32, v10
    v_sub_f32 v33, v33, v10
    v_mul_f32 v32, v32, v11
    v_mul_f32 v33, v33, v11
    v_cvt_pk_bf16_f32 v57, v32, v33
    v_lshlrev_b32 v32, 16, v58
    v_and_b32 v33, s87, v58
    v_sub_f32 v32, v32, v10
    v_sub_f32 v33, v33, v10
    v_mul_f32 v32, v32, v11
    v_mul_f32 v33, v33, v11
    v_cvt_pk_bf16_f32 v58, v32, v33
    v_lshlrev_b32 v32, 16, v59
    v_and_b32 v33, s87, v59
    v_sub_f32 v32, v32, v10
    v_sub_f32 v33, v33, v10
    v_mul_f32 v32, v32, v11
    v_mul_f32 v33, v33, v11
    v_cvt_pk_bf16_f32 v59, v32, v33
    v_lshlrev_b32 v32, 16, v60
    v_and_b32 v33, s87, v60
    v_sub_f32 v32, v32, v10
    v_sub_f32 v33, v33, v10
    v_mul_f32 v32, v32, v11
    v_mul_f32 v33, v33, v11
    v_cvt_pk_bf16_f32 v60, v32, v33
    v_lshlrev_b32 v32, 16, v61
    v_and_b32 v33, s87, v61
    v_sub_f32 v32, v32, v10
    v_sub_f32 v33, v33, v10
    v_mul_f32 v32, v32, v11
    v_mul_f32 v33, v33, v11
    v_cvt_pk_bf16_f32 v61, v32, v33
    v_lshlrev_b32 v32, 16, v62
    v_and_b32 v33, s87, v62
    v_sub_f32 v32, v32, v10
    v_sub_f32 v33, v33, v10
    v_mul_f32 v32, v32, v11
    v_mul_f32 v33, v33, v11
    v_cvt_pk_bf16_f32 v62, v32, v33
    v_lshlrev_b32 v32, 16, v63
    v_and_b32 v33, s87, v63
    v_sub_f32 v32, v32, v10
    v_sub_f32 v33, v33, v10
    v_mul_f32 v32, v32, v11
    v_mul_f32 v33, v33, v11
    v_cvt_pk_bf16_f32 v63, v32, v33
    s_mul_i32 s20, s66, 288
    s_add_u32 s8, s48, s20
    s_addc_u32 s9, s49, 0
    s_sub_u32 s10, 5308416, s20
    s_mov_b32 s11, 0x20000
    s_mul_i32 s20, s67, 144
    v_mul_u32_u24 v5, 48, v7
    v_add_u32 v5, s20, v5
    s_mov_b32 s20, 9216
    v_mul_lo_u32 v5, v5, s20
    v_lshl_add_u32 v5, v8, 4, v5
    v_mov_b32 v6, 2.0
    v_cmp_gt_u32 vcc, 54, v0
    s_nop 1
    v_cndmask_b32 v5, v6, v5, vcc
    v_mov_b32 v16, 0
    v_mov_b32 v17, 0
    v_mov_b32 v18, 0
    v_mov_b32 v19, 0
    v_mov_b32 v20, 0
    v_mov_b32 v21, 0
    v_mov_b32 v22, 0
    v_mov_b32 v23, 0
    s_mov_b32 s20, 0
    buffer_load_dwordx4 v[64:67], v5, s[8:11], s20 offen
    s_add_u32 s20, s20, 9216
    buffer_load_dwordx4 v[68:71], v5, s[8:11], s20 offen
    s_add_u32 s20, s20, 9216
    buffer_load_dwordx4 v[72:75], v5, s[8:11], s20 offen
    s_add_u32 s20, s20, 9216
    buffer_load_dwordx4 v[76:79], v5, s[8:11], s20 offen
    s_add_u32 s20, s20, 9216
    s_waitcnt vmcnt(2)
    v_perm_b32 v32, v68, v64, s84
    v_perm_b32 v33, v68, v64, s85
    v_perm_b32 v34, v69, v65, s84
    v_perm_b32 v35, v69, v65, s85
    v_dot2c_f32_bf16 v16, v40, v32
    v_dot2c_f32_bf16 v17, v40, v33
    v_dot2c_f32_bf16 v18, v40, v34
    v_dot2c_f32_bf16 v19, v40, v35
    v_perm_b32 v36, v70, v66, s84
    v_perm_b32 v37, v70, v66, s85
    v_perm_b32 v38, v71, v67, s84
    v_perm_b32 v39, v71, v67, s85
    v_dot2c_f32_bf16 v20, v40, v36
    v_dot2c_f32_bf16 v21, v40, v37
    v_dot2c_f32_bf16 v22, v40, v38
    v_dot2c_f32_bf16 v23, v40, v39
    s_waitcnt vmcnt(0)
    v_perm_b32 v32, v76, v72, s84
    v_perm_b32 v33, v76, v72, s85
    v_perm_b32 v34, v77, v73, s84
    v_perm_b32 v35, v77, v73, s85
    v_dot2c_f32_bf16 v16, v41, v32
    v_dot2c_f32_bf16 v17, v41, v33
    v_dot2c_f32_bf16 v18, v41, v34
    v_dot2c_f32_bf16 v19, v41, v35
    v_perm_b32 v36, v78, v74, s84
    v_perm_b32 v37, v78, v74, s85
    v_perm_b32 v38, v79, v75, s84
    v_perm_b32 v39, v79, v75, s85
    v_dot2c_f32_bf16 v20, v41, v36
    v_dot2c_f32_bf16 v21, v41, v37
    v_dot2c_f32_bf16 v22, v41, v38
    v_dot2c_f32_bf16 v23, v41, v39
    buffer_load_dwordx4 v[64:67], v5, s[8:11], s20 offen
    s_add_u32 s20, s20, 9216
    buffer_load_dwordx4 v[68:71], v5, s[8:11], s20 offen
    s_add_u32 s20, s20, 9216
    buffer_load_dwordx4 v[72:75], v5, s[8:11], s20 offen
    s_add_u32 s20, s20, 9216
    buffer_load_dwordx4 v[76:79], v5, s[8:11], s20 offen
    s_add_u32 s20, s20, 9216
    s_waitcnt vmcnt(2)
    v_perm_b32 v32, v68, v64, s84
    v_perm_b32 v33, v68, v64, s85
    v_perm_b32 v34, v69, v65, s84
    v_perm_b32 v35, v69, v65, s85
    v_dot2c_f32_bf16 v16, v42, v32
    v_dot2c_f32_bf16 v17, v42, v33
    v_dot2c_f32_bf16 v18, v42, v34
    v_dot2c_f32_bf16 v19, v42, v35
    v_perm_b32 v36, v70, v66, s84
    v_perm_b32 v37, v70, v66, s85
    v_perm_b32 v38, v71, v67, s84
    v_perm_b32 v39, v71, v67, s85
    v_dot2c_f32_bf16 v20, v42, v36
    v_dot2c_f32_bf16 v21, v42, v37
    v_dot2c_f32_bf16 v22, v42, v38
    v_dot2c_f32_bf16 v23, v42, v39
    s_waitcnt vmcnt(0)
    v_perm_b32 v32, v76, v72, s84
    v_perm_b32 v33, v76, v72, s85
    v_perm_b32 v34, v77, v73, s84
    v_perm_b32 v35, v77, v73, s85
    v_dot2c_f32_bf16 v16, v43, v32
    v_dot2c_f32_bf16 v17, v43, v33
    v_dot2c_f32_bf16 v18, v43, v34
    v_dot2c_f32_bf16 v19, v43, v35
    v_perm_b32 v36, v78, v74, s84
    v_perm_b32 v37, v78, v74, s85
    v_perm_b32 v38, v79, v75, s84
    v_perm_b32 v39, v79, v75, s85
    v_dot2c_f32_bf16 v20, v43, v36
    v_dot2c_f32_bf16 v21, v43, v37
    v_dot2c_f32_bf16 v22, v43, v38
    v_dot2c_f32_bf16 v23, v43, v39
    buffer_load_dwordx4 v[64:67], v5, s[8:11], s20 offen
    s_add_u32 s20, s20, 9216
    buffer_load_dwordx4 v[68:71], v5, s[8:11], s20 offen
    s_add_u32 s20, s20, 9216
    buffer_load_dwordx4 v[72:75], v5, s[8:11], s20 offen
    s_add_u32 s20, s20, 9216
    buffer_load_dwordx4 v[76:79], v5, s[8:11], s20 offen
    s_add_u32 s20, s20, 9216
    s_waitcnt vmcnt(2)
    v_perm_b32 v32, v68, v64, s84
    v_perm_b32 v33, v68, v64, s85
    v_perm_b32 v34, v69, v65, s84
    v_perm_b32 v35, v69, v65, s85
    v_dot2c_f32_bf16 v16, v44, v32
    v_dot2c_f32_bf16 v17, v44, v33
    v_dot2c_f32_bf16 v18, v44, v34
    v_dot2c_f32_bf16 v19, v44, v35
    v_perm_b32 v36, v70, v66, s84
    v_perm_b32 v37, v70, v66, s85
    v_perm_b32 v38, v71, v67, s84
    v_perm_b32 v39, v71, v67, s85
    v_dot2c_f32_bf16 v20, v44, v36
    v_dot2c_f32_bf16 v21, v44, v37
    v_dot2c_f32_bf16 v22, v44, v38
    v_dot2c_f32_bf16 v23, v44, v39
    s_waitcnt vmcnt(0)
    v_perm_b32 v32, v76, v72, s84
    v_perm_b32 v33, v76, v72, s85
    v_perm_b32 v34, v77, v73, s84
    v_perm_b32 v35, v77, v73, s85
    v_dot2c_f32_bf16 v16, v45, v32
    v_dot2c_f32_bf16 v17, v45, v33
    v_dot2c_f32_bf16 v18, v45, v34
    v_dot2c_f32_bf16 v19, v45, v35
    v_perm_b32 v36, v78, v74, s84
    v_perm_b32 v37, v78, v74, s85
    v_perm_b32 v38, v79, v75, s84
    v_perm_b32 v39, v79, v75, s85
    v_dot2c_f32_bf16 v20, v45, v36
    v_dot2c_f32_bf16 v21, v45, v37
    v_dot2c_f32_bf16 v22, v45, v38
    v_dot2c_f32_bf16 v23, v45, v39
    buffer_load_dwordx4 v[64:67], v5, s[8:11], s20 offen
    s_add_u32 s20, s20, 9216
    buffer_load_dwordx4 v[68:71], v5, s[8:11], s20 offen
    s_add_u32 s20, s20, 9216
    buffer_load_dwordx4 v[72:75], v5, s[8:11], s20 offen
    s_add_u32 s20, s20, 9216
    buffer_load_dwordx4 v[76:79], v5, s[8:11], s20 offen
    s_add_u32 s20, s20, 9216
    s_waitcnt vmcnt(2)
    v_perm_b32 v32, v68, v64, s84
    v_perm_b32 v33, v68, v64, s85
    v_perm_b32 v34, v69, v65, s84
    v_perm_b32 v35, v69, v65, s85
    v_dot2c_f32_bf16 v16, v46, v32
    v_dot2c_f32_bf16 v17, v46, v33
    v_dot2c_f32_bf16 v18, v46, v34
    v_dot2c_f32_bf16 v19, v46, v35
    v_perm_b32 v36, v70, v66, s84
    v_perm_b32 v37, v70, v66, s85
    v_perm_b32 v38, v71, v67, s84
    v_perm_b32 v39, v71, v67, s85
    v_dot2c_f32_bf16 v20, v46, v36
    v_dot2c_f32_bf16 v21, v46, v37
    v_dot2c_f32_bf16 v22, v46, v38
    v_dot2c_f32_bf16 v23, v46, v39
    s_waitcnt vmcnt(0)
    v_perm_b32 v32, v76, v72, s84
    v_perm_b32 v33, v76, v72, s85
    v_perm_b32 v34, v77, v73, s84
    v_perm_b32 v35, v77, v73, s85
    v_dot2c_f32_bf16 v16, v47, v32
    v_dot2c_f32_bf16 v17, v47, v33
    v_dot2c_f32_bf16 v18, v47, v34
    v_dot2c_f32_bf16 v19, v47, v35
    v_perm_b32 v36, v78, v74, s84
    v_perm_b32 v37, v78, v74, s85
    v_perm_b32 v38, v79, v75, s84
    v_perm_b32 v39, v79, v75, s85
    v_dot2c_f32_bf16 v20, v47, v36
    v_dot2c_f32_bf16 v21, v47, v37
    v_dot2c_f32_bf16 v22, v47, v38
    v_dot2c_f32_bf16 v23, v47, v39
    buffer_load_dwordx4 v[64:67], v5, s[8:11], s20 offen
    s_add_u32 s20, s20, 9216
    buffer_load_dwordx4 v[68:71], v5, s[8:11], s20 offen
    s_add_u32 s20, s20, 9216
    buffer_load_dwordx4 v[72:75], v5, s[8:11], s20 offen
    s_add_u32 s20, s20, 9216
    buffer_load_dwordx4 v[76:79], v5, s[8:11], s20 offen
    s_add_u32 s20, s20, 9216
    s_waitcnt vmcnt(2)
    v_perm_b32 v32, v68, v64, s84
    v_perm_b32 v33, v68, v64, s85
    v_perm_b32 v34, v69, v65, s84
    v_perm_b32 v35, v69, v65, s85
    v_dot2c_f32_bf16 v16, v48, v32
    v_dot2c_f32_bf16 v17, v48, v33
    v_dot2c_f32_bf16 v18, v48, v34
    v_dot2c_f32_bf16 v19, v48, v35
    v_perm_b32 v36, v70, v66, s84
    v_perm_b32 v37, v70, v66, s85
    v_perm_b32 v38, v71, v67, s84
    v_perm_b32 v39, v71, v67, s85
    v_dot2c_f32_bf16 v20, v48, v36
    v_dot2c_f32_bf16 v21, v48, v37
    v_dot2c_f32_bf16 v22, v48, v38
    v_dot2c_f32_bf16 v23, v48, v39
    s_waitcnt vmcnt(0)
    v_perm_b32 v32, v76, v72, s84
    v_perm_b32 v33, v76, v72, s85
    v_perm_b32 v34, v77, v73, s84
    v_perm_b32 v35, v77, v73, s85
    v_dot2c_f32_bf16 v16, v49, v32
    v_dot2c_f32_bf16 v17, v49, v33
    v_dot2c_f32_bf16 v18, v49, v34
    v_dot2c_f32_bf16 v19, v49, v35
    v_perm_b32 v36, v78, v74, s84
    v_perm_b32 v37, v78, v74, s85
    v_perm_b32 v38, v79, v75, s84
    v_perm_b32 v39, v79, v75, s85
    v_dot2c_f32_bf16 v20, v49, v36
    v_dot2c_f32_bf16 v21, v49, v37
    v_dot2c_f32_bf16 v22, v49, v38
    v_dot2c_f32_bf16 v23, v49, v39
    buffer_load_dwordx4 v[64:67], v5, s[8:11], s20 offen
    s_add_u32 s20, s20, 9216
    buffer_load_dwordx4 v[68:71], v5, s[8:11], s20 offen
    s_add_u32 s20, s20, 9216
    buffer_load_dwordx4 v[72:75], v5, s[8:11], s20 offen
    s_add_u32 s20, s20, 9216
    buffer_load_dwordx4 v[76:79], v5, s[8:11], s20 offen
    s_add_u32 s20, s20, 9216
    s_waitcnt vmcnt(2)
    v_perm_b32 v32, v68, v64, s84
    v_perm_b32 v33, v68, v64, s85
    v_perm_b32 v34, v69, v65, s84
    v_perm_b32 v35, v69, v65, s85
    v_dot2c_f32_bf16 v16, v50, v32
    v_dot2c_f32_bf16 v17, v50, v33
    v_dot2c_f32_bf16 v18, v50, v34
    v_dot2c_f32_bf16 v19, v50, v35
    v_perm_b32 v36, v70, v66, s84
    v_perm_b32 v37, v70, v66, s85
    v_perm_b32 v38, v71, v67, s84
    v_perm_b32 v39, v71, v67, s85
    v_dot2c_f32_bf16 v20, v50, v36
    v_dot2c_f32_bf16 v21, v50, v37
    v_dot2c_f32_bf16 v22, v50, v38
    v_dot2c_f32_bf16 v23, v50, v39
    s_waitcnt vmcnt(0)
    v_perm_b32 v32, v76, v72, s84
    v_perm_b32 v33, v76, v72, s85
    v_perm_b32 v34, v77, v73, s84
    v_perm_b32 v35, v77, v73, s85
    v_dot2c_f32_bf16 v16, v51, v32
    v_dot2c_f32_bf16 v17, v51, v33
    v_dot2c_f32_bf16 v18, v51, v34
    v_dot2c_f32_bf16 v19, v51, v35
    v_perm_b32 v36, v78, v74, s84
    v_perm_b32 v37, v78, v74, s85
    v_perm_b32 v38, v79, v75, s84
    v_perm_b32 v39, v79, v75, s85
    v_dot2c_f32_bf16 v20, v51, v36
    v_dot2c_f32_bf16 v21, v51, v37
    v_dot2c_f32_bf16 v22, v51, v38
    v_dot2c_f32_bf16 v23, v51, v39
    buffer_load_dwordx4 v[64:67], v5, s[8:11], s20 offen
    s_add_u32 s20, s20, 9216
    buffer_load_dwordx4 v[68:71], v5, s[8:11], s20 offen
    s_add_u32 s20, s20, 9216
    buffer_load_dwordx4 v[72:75], v5, s[8:11], s20 offen
    s_add_u32 s20, s20, 9216
    buffer_load_dwordx4 v[76:79], v5, s[8:11], s20 offen
    s_add_u32 s20, s20, 9216
    s_waitcnt vmcnt(2)
    v_perm_b32 v32, v68, v64, s84
    v_perm_b32 v33, v68, v64, s85
    v_perm_b32 v34, v69, v65, s84
    v_perm_b32 v35, v69, v65, s85
    v_dot2c_f32_bf16 v16, v52, v32
    v_dot2c_f32_bf16 v17, v52, v33
    v_dot2c_f32_bf16 v18, v52, v34
    v_dot2c_f32_bf16 v19, v52, v35
    v_perm_b32 v36, v70, v66, s84
    v_perm_b32 v37, v70, v66, s85
    v_perm_b32 v38, v71, v67, s84
    v_perm_b32 v39, v71, v67, s85
    v_dot2c_f32_bf16 v20, v52, v36
    v_dot2c_f32_bf16 v21, v52, v37
    v_dot2c_f32_bf16 v22, v52, v38
    v_dot2c_f32_bf16 v23, v52, v39
    s_waitcnt vmcnt(0)
    v_perm_b32 v32, v76, v72, s84
    v_perm_b32 v33, v76, v72, s85
    v_perm_b32 v34, v77, v73, s84
    v_perm_b32 v35, v77, v73, s85
    v_dot2c_f32_bf16 v16, v53, v32
    v_dot2c_f32_bf16 v17, v53, v33
    v_dot2c_f32_bf16 v18, v53, v34
    v_dot2c_f32_bf16 v19, v53, v35
    v_perm_b32 v36, v78, v74, s84
    v_perm_b32 v37, v78, v74, s85
    v_perm_b32 v38, v79, v75, s84
    v_perm_b32 v39, v79, v75, s85
    v_dot2c_f32_bf16 v20, v53, v36
    v_dot2c_f32_bf16 v21, v53, v37
    v_dot2c_f32_bf16 v22, v53, v38
    v_dot2c_f32_bf16 v23, v53, v39
    buffer_load_dwordx4 v[64:67], v5, s[8:11], s20 offen
    s_add_u32 s20, s20, 9216
    buffer_load_dwordx4 v[68:71], v5, s[8:11], s20 offen
    s_add_u32 s20, s20, 9216
    buffer_load_dwordx4 v[72:75], v5, s[8:11], s20 offen
    s_add_u32 s20, s20, 9216
    buffer_load_dwordx4 v[76:79], v5, s[8:11], s20 offen
    s_add_u32 s20, s20, 9216
    s_waitcnt vmcnt(2)
    v_perm_b32 v32, v68, v64, s84
    v_perm_b32 v33, v68, v64, s85
    v_perm_b32 v34, v69, v65, s84
    v_perm_b32 v35, v69, v65, s85
    v_dot2c_f32_bf16 v16, v54, v32
    v_dot2c_f32_bf16 v17, v54, v33
    v_dot2c_f32_bf16 v18, v54, v34
    v_dot2c_f32_bf16 v19, v54, v35
    v_perm_b32 v36, v70, v66, s84
    v_perm_b32 v37, v70, v66, s85
    v_perm_b32 v38, v71, v67, s84
    v_perm_b32 v39, v71, v67, s85
    v_dot2c_f32_bf16 v20, v54, v36
    v_dot2c_f32_bf16 v21, v54, v37
    v_dot2c_f32_bf16 v22, v54, v38
    v_dot2c_f32_bf16 v23, v54, v39
    s_waitcnt vmcnt(0)
    v_perm_b32 v32, v76, v72, s84
    v_perm_b32 v33, v76, v72, s85
    v_perm_b32 v34, v77, v73, s84
    v_perm_b32 v35, v77, v73, s85
    v_dot2c_f32_bf16 v16, v55, v32
    v_dot2c_f32_bf16 v17, v55, v33
    v_dot2c_f32_bf16 v18, v55, v34
    v_dot2c_f32_bf16 v19, v55, v35
    v_perm_b32 v36, v78, v74, s84
    v_perm_b32 v37, v78, v74, s85
    v_perm_b32 v38, v79, v75, s84
    v_perm_b32 v39, v79, v75, s85
    v_dot2c_f32_bf16 v20, v55, v36
    v_dot2c_f32_bf16 v21, v55, v37
    v_dot2c_f32_bf16 v22, v55, v38
    v_dot2c_f32_bf16 v23, v55, v39
    buffer_load_dwordx4 v[64:67], v5, s[8:11], s20 offen
    s_add_u32 s20, s20, 9216
    buffer_load_dwordx4 v[68:71], v5, s[8:11], s20 offen
    s_add_u32 s20, s20, 9216
    buffer_load_dwordx4 v[72:75], v5, s[8:11], s20 offen
    s_add_u32 s20, s20, 9216
    buffer_load_dwordx4 v[76:79], v5, s[8:11], s20 offen
    s_add_u32 s20, s20, 9216
    s_waitcnt vmcnt(2)
    v_perm_b32 v32, v68, v64, s84
    v_perm_b32 v33, v68, v64, s85
    v_perm_b32 v34, v69, v65, s84
    v_perm_b32 v35, v69, v65, s85
    v_dot2c_f32_bf16 v16, v56, v32
    v_dot2c_f32_bf16 v17, v56, v33
    v_dot2c_f32_bf16 v18, v56, v34
    v_dot2c_f32_bf16 v19, v56, v35
    v_perm_b32 v36, v70, v66, s84
    v_perm_b32 v37, v70, v66, s85
    v_perm_b32 v38, v71, v67, s84
    v_perm_b32 v39, v71, v67, s85
    v_dot2c_f32_bf16 v20, v56, v36
    v_dot2c_f32_bf16 v21, v56, v37
    v_dot2c_f32_bf16 v22, v56, v38
    v_dot2c_f32_bf16 v23, v56, v39
    s_waitcnt vmcnt(0)
    v_perm_b32 v32, v76, v72, s84
    v_perm_b32 v33, v76, v72, s85
    v_perm_b32 v34, v77, v73, s84
    v_perm_b32 v35, v77, v73, s85
    v_dot2c_f32_bf16 v16, v57, v32
    v_dot2c_f32_bf16 v17, v57, v33
    v_dot2c_f32_bf16 v18, v57, v34
    v_dot2c_f32_bf16 v19, v57, v35
    v_perm_b32 v36, v78, v74, s84
    v_perm_b32 v37, v78, v74, s85
    v_perm_b32 v38, v79, v75, s84
    v_perm_b32 v39, v79, v75, s85
    v_dot2c_f32_bf16 v20, v57, v36
    v_dot2c_f32_bf16 v21, v57, v37
    v_dot2c_f32_bf16 v22, v57, v38
    v_dot2c_f32_bf16 v23, v57, v39
    buffer_load_dwordx4 v[64:67], v5, s[8:11], s20 offen
    s_add_u32 s20, s20, 9216
    buffer_load_dwordx4 v[68:71], v5, s[8:11], s20 offen
    s_add_u32 s20, s20, 9216
    buffer_load_dwordx4 v[72:75], v5, s[8:11], s20 offen
    s_add_u32 s20, s20, 9216
    buffer_load_dwordx4 v[76:79], v5, s[8:11], s20 offen
    s_add_u32 s20, s20, 9216
    s_waitcnt vmcnt(2)
    v_perm_b32 v32, v68, v64, s84
    v_perm_b32 v33, v68, v64, s85
    v_perm_b32 v34, v69, v65, s84
    v_perm_b32 v35, v69, v65, s85
    v_dot2c_f32_bf16 v16, v58, v32
    v_dot2c_f32_bf16 v17, v58, v33
    v_dot2c_f32_bf16 v18, v58, v34
    v_dot2c_f32_bf16 v19, v58, v35
    v_perm_b32 v36, v70, v66, s84
    v_perm_b32 v37, v70, v66, s85
    v_perm_b32 v38, v71, v67, s84
    v_perm_b32 v39, v71, v67, s85
    v_dot2c_f32_bf16 v20, v58, v36
    v_dot2c_f32_bf16 v21, v58, v37
    v_dot2c_f32_bf16 v22, v58, v38
    v_dot2c_f32_bf16 v23, v58, v39
    s_waitcnt vmcnt(0)
    v_perm_b32 v32, v76, v72, s84
    v_perm_b32 v33, v76, v72, s85
    v_perm_b32 v34, v77, v73, s84
    v_perm_b32 v35, v77, v73, s85
    v_dot2c_f32_bf16 v16, v59, v32
    v_dot2c_f32_bf16 v17, v59, v33
    v_dot2c_f32_bf16 v18, v59, v34
    v_dot2c_f32_bf16 v19, v59, v35
    v_perm_b32 v36, v78, v74, s84
    v_perm_b32 v37, v78, v74, s85
    v_perm_b32 v38, v79, v75, s84
    v_perm_b32 v39, v79, v75, s85
    v_dot2c_f32_bf16 v20, v59, v36
    v_dot2c_f32_bf16 v21, v59, v37
    v_dot2c_f32_bf16 v22, v59, v38
    v_dot2c_f32_bf16 v23, v59, v39
    buffer_load_dwordx4 v[64:67], v5, s[8:11], s20 offen
    s_add_u32 s20, s20, 9216
    buffer_load_dwordx4 v[68:71], v5, s[8:11], s20 offen
    s_add_u32 s20, s20, 9216
    buffer_load_dwordx4 v[72:75], v5, s[8:11], s20 offen
    s_add_u32 s20, s20, 9216
    buffer_load_dwordx4 v[76:79], v5, s[8:11], s20 offen
    s_add_u32 s20, s20, 9216
    s_waitcnt vmcnt(2)
    v_perm_b32 v32, v68, v64, s84
    v_perm_b32 v33, v68, v64, s85
    v_perm_b32 v34, v69, v65, s84
    v_perm_b32 v35, v69, v65, s85
    v_dot2c_f32_bf16 v16, v60, v32
    v_dot2c_f32_bf16 v17, v60, v33
    v_dot2c_f32_bf16 v18, v60, v34
    v_dot2c_f32_bf16 v19, v60, v35
    v_perm_b32 v36, v70, v66, s84
    v_perm_b32 v37, v70, v66, s85
    v_perm_b32 v38, v71, v67, s84
    v_perm_b32 v39, v71, v67, s85
    v_dot2c_f32_bf16 v20, v60, v36
    v_dot2c_f32_bf16 v21, v60, v37
    v_dot2c_f32_bf16 v22, v60, v38
    v_dot2c_f32_bf16 v23, v60, v39
    s_waitcnt vmcnt(0)
    v_perm_b32 v32, v76, v72, s84
    v_perm_b32 v33, v76, v72, s85
    v_perm_b32 v34, v77, v73, s84
    v_perm_b32 v35, v77, v73, s85
    v_dot2c_f32_bf16 v16, v61, v32
    v_dot2c_f32_bf16 v17, v61, v33
    v_dot2c_f32_bf16 v18, v61, v34
    v_dot2c_f32_bf16 v19, v61, v35
    v_perm_b32 v36, v78, v74, s84
    v_perm_b32 v37, v78, v74, s85
    v_perm_b32 v38, v79, v75, s84
    v_perm_b32 v39, v79, v75, s85
    v_dot2c_f32_bf16 v20, v61, v36
    v_dot2c_f32_bf16 v21, v61, v37
    v_dot2c_f32_bf16 v22, v61, v38
    v_dot2c_f32_bf16 v23, v61, v39
    buffer_load_dwordx4 v[64:67], v5, s[8:11], s20 offen
    s_add_u32 s20, s20, 9216
    buffer_load_dwordx4 v[68:71], v5, s[8:11], s20 offen
    s_add_u32 s20, s20, 9216
    buffer_load_dwordx4 v[72:75], v5, s[8:11], s20 offen
    s_add_u32 s20, s20, 9216
    buffer_load_dwordx4 v[76:79], v5, s[8:11], s20 offen
    s_add_u32 s20, s20, 9216
    s_waitcnt vmcnt(2)
    v_perm_b32 v32, v68, v64, s84
    v_perm_b32 v33, v68, v64, s85
    v_perm_b32 v34, v69, v65, s84
    v_perm_b32 v35, v69, v65, s85
    v_dot2c_f32_bf16 v16, v62, v32
    v_dot2c_f32_bf16 v17, v62, v33
    v_dot2c_f32_bf16 v18, v62, v34
    v_dot2c_f32_bf16 v19, v62, v35
    v_perm_b32 v36, v70, v66, s84
    v_perm_b32 v37, v70, v66, s85
    v_perm_b32 v38, v71, v67, s84
    v_perm_b32 v39, v71, v67, s85
    v_dot2c_f32_bf16 v20, v62, v36
    v_dot2c_f32_bf16 v21, v62, v37
    v_dot2c_f32_bf16 v22, v62, v38
    v_dot2c_f32_bf16 v23, v62, v39
    s_waitcnt vmcnt(0)
    v_perm_b32 v32, v76, v72, s84
    v_perm_b32 v33, v76, v72, s85
    v_perm_b32 v34, v77, v73, s84
    v_perm_b32 v35, v77, v73, s85
    v_dot2c_f32_bf16 v16, v63, v32
    v_dot2c_f32_bf16 v17, v63, v33
    v_dot2c_f32_bf16 v18, v63, v34
    v_dot2c_f32_bf16 v19, v63, v35
    v_perm_b32 v36, v78, v74, s84
    v_perm_b32 v37, v78, v74, s85
    v_perm_b32 v38, v79, v75, s84
    v_perm_b32 v39, v79, v75, s85
    v_dot2c_f32_bf16 v20, v63, v36
    v_dot2c_f32_bf16 v21, v63, v37
    v_dot2c_f32_bf16 v22, v63, v38
    v_dot2c_f32_bf16 v23, v63, v39
    s_mul_i32 s20, s67, 3
    v_add_u32 v6, s20, v7
    v_mul_u32_u24 v6, 576, v6
    v_lshl_add_u32 v6, v8, 5, v6
    s_mov_b32 exec_hi, 0x003fffff
    ds_write_b128 v6, v[16:19] offset:2048
    ds_write_b128 v6, v[20:23] offset:2064
    s_mov_b64 exec, -1
    s_mul_i32 s20, s66, 288
    s_add_u32 s16, s50, s20
    s_addc_u32 s17, s51, 0
    s_mov_b32 s18, 288
    s_mov_b32 s19, 0x20000
    s_mul_i32 s20, s67, 36
    v_add_u32 v6, s20, v0
    v_lshlrev_b32 v9, 1, v6
    buffer_load_ushort v14, v9, s[16:19], 0 offen
    s_waitcnt lgkmcnt(0)
    v_mov_b32 v4, 9376
    v_mov_b32 v15, 1
    s_mov_b64 exec, 1
    ds_add_u32 v4, v15
    s_mov_b64 exec, -1
L_hsync:
    ds_read_b32 v15, v4
    s_waitcnt lgkmcnt(0)
    v_readfirstlane_b32 s20, v15
    s_cmp_ge_u32 s20, 4
    s_cbranch_scc1 L_hsync_done
    s_sleep 2
    s_branch L_hsync
L_hsync_done:
    s_cmp_lg_u32 s67, 0
    s_cbranch_scc1 L_noclrcnt
    v_mov_b32 v15, 0x10000
    v_mov_b32 v4, 0
    s_mov_b64 exec, 1
    buffer_atomic_add v15, v4, s[28:31], 0 offen
    s_mov_b64 exec, -1
L_noclrcnt:
    v_lshlrev_b32 v6, 2, v6
    ds_read_b32 v64, v6 offset:2048
    ds_read_b32 v65, v6 offset:2624
    ds_read_b32 v66, v6 offset:3200
    ds_read_b32 v67, v6 offset:3776
    ds_read_b32 v68, v6 offset:4352
    ds_read_b32 v69, v6 offset:4928
    ds_read_b32 v70, v6 offset:5504
    ds_read_b32 v71, v6 offset:6080
    ds_read_b32 v72, v6 offset:6656
    ds_read_b32 v73, v6 offset:7232
    ds_read_b32 v74, v6 offset:7808
    ds_read_b32 v75, v6 offset:8384
    s_waitcnt vmcnt(0) lgkmcnt(0)
    v_lshlrev_b32 v14, 16, v14
    v_add_f32 v14, v14, v64
    v_add_f32 v14, v14, v65
    v_add_f32 v14, v14, v66
    v_add_f32 v14, v14, v67
    v_add_f32 v14, v14, v68
    v_add_f32 v14, v14, v69
    v_add_f32 v14, v14, v70
    v_add_f32 v14, v14, v71
    v_add_f32 v14, v14, v72
    v_add_f32 v14, v14, v73
    v_add_f32 v14, v14, v74
    v_add_f32 v14, v14, v75
    v_mul_f32 v15, v14, v14
    v_mul_f32 v15, 0x3d372713, v15
    v_add_f32 v15, 1.0, v15
    v_mul_f32 v15, v15, v14
    v_mul_f32 v15, 0xc0135761, v15
    v_exp_f32 v15, v15
    s_nop 0
    v_add_f32 v15, 1.0, v15
    v_rcp_f32 v15, v15
    s_nop 0
    v_mul_f32 v14, v14, v15
    v_cvt_pk_bf16_f32 v14, v14, v14
    s_mul_i32 s20, s67, 72
    v_lshlrev_b32 v6, 1, v0
    v_add_u32 v6, s20, v6
    s_mov_b32 exec_hi, 0x0000000f
    ds_write_b16 v6, v14 offset:8960
    s_mov_b64 exec, -1
    s_waitcnt lgkmcnt(0)
    v_mov_b32 v4, 9376
    v_mov_b32 v15, 1
    s_mov_b64 exec, 1
    ds_add_u32 v4, v15
    s_mov_b64 exec, -1
L_hsync2:
    ds_read_b32 v15, v4
    s_waitcnt lgkmcnt(0)
    v_readfirstlane_b32 s20, v15
    s_cmp_ge_u32 s20, 8
    s_cbranch_scc1 L_hsync2_done
    s_sleep 2
    s_branch L_hsync2
L_hsync2_done:
    v_lshrrev_b32 v2, 4, v0
    v_and_b32 v3, 15, v0
    v_mul_u32_u24 v6, 72, v2
    ds_read_b64 v[40:41], v6 offset:8960
    ds_read_b64 v[42:43], v6 offset:8968
    ds_read_b64 v[44:45], v6 offset:8976
    ds_read_b64 v[46:47], v6 offset:8984
    ds_read_b64 v[48:49], v6 offset:8992
    ds_read_b64 v[50:51], v6 offset:9000
    ds_read_b64 v[52:53], v6 offset:9008
    ds_read_b64 v[54:55], v6 offset:9016
    ds_read_b64 v[56:57], v6 offset:9024
    v_lshrrev_b32 v7, 3, v0
    v_and_b32 v8, 7, v0
    s_mul_i32 s20, s67, 72
    v_lshlrev_b32 v6, 2, v7
    v_add_u32 v6, s20, v6
    ds_read_b32 v58, v6 offset:8960
    ds_read_b32 v59, v6 offset:8992
    ds_read_b32 v60, v6 offset:9024
    s_cmp_eq_u32 s65, 0
    s_cselect_b32 s18, 1152, 0
    s_mov_b32 s16, s54
    s_mov_b32 s17, s55
    s_mov_b32 s19, 0x20000
    s_lshl_b32 s20, s67, 8
    v_lshlrev_b32 v5, 4, v3
    v_add_u32 v5, s20, v5
    v_mov_b32 v6, 2.0
    v_cmp_gt_u32 vcc, 16, v0
    s_nop 1
    v_cndmask_b32 v9, v6, v5, vcc
    buffer_load_dwordx4 v[64:67], v9, s[16:19], 0 offen
    s_cmp_eq_u32 s67, 0
    s_cselect_b32 s18, s18, 0
    v_add_u32 v9, 1024, v1
    buffer_load_dwordx4 v[68:71], v9, s[16:19], 0 offen
    s_mul_i32 s20, s66, 165888
    s_add_u32 s8, s52, s20
    s_addc_u32 s9, s53, 0
    s_sub_u32 s10, 5308416, s20
    s_mov_b32 s11, 0x20000
    v_mul_u32_u24 v6, 41472, v2
    v_add_u32 v5, v5, v6
    v_mul_u32_u24 v14, 2304, v7
    v_lshl_add_u32 v14, v8, 4, v14
    v_add_u32 v14, 1024, v14
    s_mul_i32 s20, s67, 41472
    v_add_u32 v9, s20, v14
    v_mov_b32 v6, 2.0
    v_cmp_gt_u32 vcc, 2, v7
    s_nop 1
    v_cndmask_b32 v15, v6, v9, vcc
    s_waitcnt vmcnt(0) lgkmcnt(0)
    v_lshlrev_b32 v16, 16, v64
    v_and_b32 v17, s87, v64
    v_lshlrev_b32 v24, 16, v68
    v_and_b32 v25, s87, v68
    v_lshlrev_b32 v18, 16, v65
    v_and_b32 v19, s87, v65
    v_lshlrev_b32 v26, 16, v69
    v_and_b32 v27, s87, v69
    v_lshlrev_b32 v20, 16, v66
    v_and_b32 v21, s87, v66
    v_lshlrev_b32 v28, 16, v70
    v_and_b32 v29, s87, v70
    v_lshlrev_b32 v22, 16, v67
    v_and_b32 v23, s87, v67
    v_lshlrev_b32 v30, 16, v71
    v_and_b32 v31, s87, v71
    s_mov_b32 s20, 0
    buffer_load_dwordx4 v[64:67], v5, s[8:11], s20 offen
    s_add_u32 s20, s20, 1152
    buffer_load_dwordx4 v[68:71], v5, s[8:11], s20 offen
    s_add_u32 s20, s20, 1152
    buffer_load_dwordx4 v[72:75], v5, s[8:11], s20 offen
    s_add_u32 s20, s20, 1152
    buffer_load_dwordx4 v[76:79], v5, s[8:11], s20 offen
    s_add_u32 s20, s20, 1152
    s_waitcnt vmcnt(2)
    v_perm_b32 v32, v68, v64, s84
    v_perm_b32 v33, v68, v64, s85
    v_perm_b32 v34, v69, v65, s84
    v_perm_b32 v35, v69, v65, s85
    v_dot2c_f32_bf16 v16, v40, v32
    v_dot2c_f32_bf16 v17, v40, v33
    v_dot2c_f32_bf16 v18, v40, v34
    v_dot2c_f32_bf16 v19, v40, v35
    v_perm_b32 v36, v70, v66, s84
    v_perm_b32 v37, v70, v66, s85
    v_perm_b32 v38, v71, v67, s84
    v_perm_b32 v39, v71, v67, s85
    v_dot2c_f32_bf16 v20, v40, v36
    v_dot2c_f32_bf16 v21, v40, v37
    v_dot2c_f32_bf16 v22, v40, v38
    v_dot2c_f32_bf16 v23, v40, v39
    s_waitcnt vmcnt(0)
    v_perm_b32 v32, v76, v72, s84
    v_perm_b32 v33, v76, v72, s85
    v_perm_b32 v34, v77, v73, s84
    v_perm_b32 v35, v77, v73, s85
    v_dot2c_f32_bf16 v16, v41, v32
    v_dot2c_f32_bf16 v17, v41, v33
    v_dot2c_f32_bf16 v18, v41, v34
    v_dot2c_f32_bf16 v19, v41, v35
    v_perm_b32 v36, v78, v74, s84
    v_perm_b32 v37, v78, v74, s85
    v_perm_b32 v38, v79, v75, s84
    v_perm_b32 v39, v79, v75, s85
    v_dot2c_f32_bf16 v20, v41, v36
    v_dot2c_f32_bf16 v21, v41, v37
    v_dot2c_f32_bf16 v22, v41, v38
    v_dot2c_f32_bf16 v23, v41, v39
    buffer_load_dwordx4 v[64:67], v5, s[8:11], s20 offen
    s_add_u32 s20, s20, 1152
    buffer_load_dwordx4 v[68:71], v5, s[8:11], s20 offen
    s_add_u32 s20, s20, 1152
    buffer_load_dwordx4 v[72:75], v5, s[8:11], s20 offen
    s_add_u32 s20, s20, 1152
    buffer_load_dwordx4 v[76:79], v5, s[8:11], s20 offen
    s_add_u32 s20, s20, 1152
    s_waitcnt vmcnt(2)
    v_perm_b32 v32, v68, v64, s84
    v_perm_b32 v33, v68, v64, s85
    v_perm_b32 v34, v69, v65, s84
    v_perm_b32 v35, v69, v65, s85
    v_dot2c_f32_bf16 v16, v42, v32
    v_dot2c_f32_bf16 v17, v42, v33
    v_dot2c_f32_bf16 v18, v42, v34
    v_dot2c_f32_bf16 v19, v42, v35
    v_perm_b32 v36, v70, v66, s84
    v_perm_b32 v37, v70, v66, s85
    v_perm_b32 v38, v71, v67, s84
    v_perm_b32 v39, v71, v67, s85
    v_dot2c_f32_bf16 v20, v42, v36
    v_dot2c_f32_bf16 v21, v42, v37
    v_dot2c_f32_bf16 v22, v42, v38
    v_dot2c_f32_bf16 v23, v42, v39
    s_waitcnt vmcnt(0)
    v_perm_b32 v32, v76, v72, s84
    v_perm_b32 v33, v76, v72, s85
    v_perm_b32 v34, v77, v73, s84
    v_perm_b32 v35, v77, v73, s85
    v_dot2c_f32_bf16 v16, v43, v32
    v_dot2c_f32_bf16 v17, v43, v33
    v_dot2c_f32_bf16 v18, v43, v34
    v_dot2c_f32_bf16 v19, v43, v35
    v_perm_b32 v36, v78, v74, s84
    v_perm_b32 v37, v78, v74, s85
    v_perm_b32 v38, v79, v75, s84
    v_perm_b32 v39, v79, v75, s85
    v_dot2c_f32_bf16 v20, v43, v36
    v_dot2c_f32_bf16 v21, v43, v37
    v_dot2c_f32_bf16 v22, v43, v38
    v_dot2c_f32_bf16 v23, v43, v39
    buffer_load_dwordx4 v[64:67], v5, s[8:11], s20 offen
    s_add_u32 s20, s20, 1152
    buffer_load_dwordx4 v[68:71], v5, s[8:11], s20 offen
    s_add_u32 s20, s20, 1152
    buffer_load_dwordx4 v[72:75], v5, s[8:11], s20 offen
    s_add_u32 s20, s20, 1152
    buffer_load_dwordx4 v[76:79], v5, s[8:11], s20 offen
    s_add_u32 s20, s20, 1152
    s_waitcnt vmcnt(2)
    v_perm_b32 v32, v68, v64, s84
    v_perm_b32 v33, v68, v64, s85
    v_perm_b32 v34, v69, v65, s84
    v_perm_b32 v35, v69, v65, s85
    v_dot2c_f32_bf16 v16, v44, v32
    v_dot2c_f32_bf16 v17, v44, v33
    v_dot2c_f32_bf16 v18, v44, v34
    v_dot2c_f32_bf16 v19, v44, v35
    v_perm_b32 v36, v70, v66, s84
    v_perm_b32 v37, v70, v66, s85
    v_perm_b32 v38, v71, v67, s84
    v_perm_b32 v39, v71, v67, s85
    v_dot2c_f32_bf16 v20, v44, v36
    v_dot2c_f32_bf16 v21, v44, v37
    v_dot2c_f32_bf16 v22, v44, v38
    v_dot2c_f32_bf16 v23, v44, v39
    s_waitcnt vmcnt(0)
    v_perm_b32 v32, v76, v72, s84
    v_perm_b32 v33, v76, v72, s85
    v_perm_b32 v34, v77, v73, s84
    v_perm_b32 v35, v77, v73, s85
    v_dot2c_f32_bf16 v16, v45, v32
    v_dot2c_f32_bf16 v17, v45, v33
    v_dot2c_f32_bf16 v18, v45, v34
    v_dot2c_f32_bf16 v19, v45, v35
    v_perm_b32 v36, v78, v74, s84
    v_perm_b32 v37, v78, v74, s85
    v_perm_b32 v38, v79, v75, s84
    v_perm_b32 v39, v79, v75, s85
    v_dot2c_f32_bf16 v20, v45, v36
    v_dot2c_f32_bf16 v21, v45, v37
    v_dot2c_f32_bf16 v22, v45, v38
    v_dot2c_f32_bf16 v23, v45, v39
    buffer_load_dwordx4 v[64:67], v5, s[8:11], s20 offen
    s_add_u32 s20, s20, 1152
    buffer_load_dwordx4 v[68:71], v5, s[8:11], s20 offen
    s_add_u32 s20, s20, 1152
    buffer_load_dwordx4 v[72:75], v5, s[8:11], s20 offen
    s_add_u32 s20, s20, 1152
    buffer_load_dwordx4 v[76:79], v5, s[8:11], s20 offen
    s_add_u32 s20, s20, 1152
    s_waitcnt vmcnt(2)
    v_perm_b32 v32, v68, v64, s84
    v_perm_b32 v33, v68, v64, s85
    v_perm_b32 v34, v69, v65, s84
    v_perm_b32 v35, v69, v65, s85
    v_dot2c_f32_bf16 v16, v46, v32
    v_dot2c_f32_bf16 v17, v46, v33
    v_dot2c_f32_bf16 v18, v46, v34
    v_dot2c_f32_bf16 v19, v46, v35
    v_perm_b32 v36, v70, v66, s84
    v_perm_b32 v37, v70, v66, s85
    v_perm_b32 v38, v71, v67, s84
    v_perm_b32 v39, v71, v67, s85
    v_dot2c_f32_bf16 v20, v46, v36
    v_dot2c_f32_bf16 v21, v46, v37
    v_dot2c_f32_bf16 v22, v46, v38
    v_dot2c_f32_bf16 v23, v46, v39
    s_waitcnt vmcnt(0)
    v_perm_b32 v32, v76, v72, s84
    v_perm_b32 v33, v76, v72, s85
    v_perm_b32 v34, v77, v73, s84
    v_perm_b32 v35, v77, v73, s85
    v_dot2c_f32_bf16 v16, v47, v32
    v_dot2c_f32_bf16 v17, v47, v33
    v_dot2c_f32_bf16 v18, v47, v34
    v_dot2c_f32_bf16 v19, v47, v35
    v_perm_b32 v36, v78, v74, s84
    v_perm_b32 v37, v78, v74, s85
    v_perm_b32 v38, v79, v75, s84
    v_perm_b32 v39, v79, v75, s85
    v_dot2c_f32_bf16 v20, v47, v36
    v_dot2c_f32_bf16 v21, v47, v37
    v_dot2c_f32_bf16 v22, v47, v38
    v_dot2c_f32_bf16 v23, v47, v39
    buffer_load_dwordx4 v[64:67], v5, s[8:11], s20 offen
    s_add_u32 s20, s20, 1152
    buffer_load_dwordx4 v[68:71], v5, s[8:11], s20 offen
    s_add_u32 s20, s20, 1152
    buffer_load_dwordx4 v[72:75], v5, s[8:11], s20 offen
    s_add_u32 s20, s20, 1152
    buffer_load_dwordx4 v[76:79], v5, s[8:11], s20 offen
    s_add_u32 s20, s20, 1152
    s_waitcnt vmcnt(2)
    v_perm_b32 v32, v68, v64, s84
    v_perm_b32 v33, v68, v64, s85
    v_perm_b32 v34, v69, v65, s84
    v_perm_b32 v35, v69, v65, s85
    v_dot2c_f32_bf16 v16, v48, v32
    v_dot2c_f32_bf16 v17, v48, v33
    v_dot2c_f32_bf16 v18, v48, v34
    v_dot2c_f32_bf16 v19, v48, v35
    v_perm_b32 v36, v70, v66, s84
    v_perm_b32 v37, v70, v66, s85
    v_perm_b32 v38, v71, v67, s84
    v_perm_b32 v39, v71, v67, s85
    v_dot2c_f32_bf16 v20, v48, v36
    v_dot2c_f32_bf16 v21, v48, v37
    v_dot2c_f32_bf16 v22, v48, v38
    v_dot2c_f32_bf16 v23, v48, v39
    s_waitcnt vmcnt(0)
    v_perm_b32 v32, v76, v72, s84
    v_perm_b32 v33, v76, v72, s85
    v_perm_b32 v34, v77, v73, s84
    v_perm_b32 v35, v77, v73, s85
    v_dot2c_f32_bf16 v16, v49, v32
    v_dot2c_f32_bf16 v17, v49, v33
    v_dot2c_f32_bf16 v18, v49, v34
    v_dot2c_f32_bf16 v19, v49, v35
    v_perm_b32 v36, v78, v74, s84
    v_perm_b32 v37, v78, v74, s85
    v_perm_b32 v38, v79, v75, s84
    v_perm_b32 v39, v79, v75, s85
    v_dot2c_f32_bf16 v20, v49, v36
    v_dot2c_f32_bf16 v21, v49, v37
    v_dot2c_f32_bf16 v22, v49, v38
    v_dot2c_f32_bf16 v23, v49, v39
    buffer_load_dwordx4 v[64:67], v5, s[8:11], s20 offen
    s_add_u32 s20, s20, 1152
    buffer_load_dwordx4 v[68:71], v5, s[8:11], s20 offen
    s_add_u32 s20, s20, 1152
    buffer_load_dwordx4 v[72:75], v5, s[8:11], s20 offen
    s_add_u32 s20, s20, 1152
    buffer_load_dwordx4 v[76:79], v5, s[8:11], s20 offen
    s_add_u32 s20, s20, 1152
    s_waitcnt vmcnt(2)
    v_perm_b32 v32, v68, v64, s84
    v_perm_b32 v33, v68, v64, s85
    v_perm_b32 v34, v69, v65, s84
    v_perm_b32 v35, v69, v65, s85
    v_dot2c_f32_bf16 v16, v50, v32
    v_dot2c_f32_bf16 v17, v50, v33
    v_dot2c_f32_bf16 v18, v50, v34
    v_dot2c_f32_bf16 v19, v50, v35
    v_perm_b32 v36, v70, v66, s84
    v_perm_b32 v37, v70, v66, s85
    v_perm_b32 v38, v71, v67, s84
    v_perm_b32 v39, v71, v67, s85
    v_dot2c_f32_bf16 v20, v50, v36
    v_dot2c_f32_bf16 v21, v50, v37
    v_dot2c_f32_bf16 v22, v50, v38
    v_dot2c_f32_bf16 v23, v50, v39
    s_waitcnt vmcnt(0)
    v_perm_b32 v32, v76, v72, s84
    v_perm_b32 v33, v76, v72, s85
    v_perm_b32 v34, v77, v73, s84
    v_perm_b32 v35, v77, v73, s85
    v_dot2c_f32_bf16 v16, v51, v32
    v_dot2c_f32_bf16 v17, v51, v33
    v_dot2c_f32_bf16 v18, v51, v34
    v_dot2c_f32_bf16 v19, v51, v35
    v_perm_b32 v36, v78, v74, s84
    v_perm_b32 v37, v78, v74, s85
    v_perm_b32 v38, v79, v75, s84
    v_perm_b32 v39, v79, v75, s85
    v_dot2c_f32_bf16 v20, v51, v36
    v_dot2c_f32_bf16 v21, v51, v37
    v_dot2c_f32_bf16 v22, v51, v38
    v_dot2c_f32_bf16 v23, v51, v39
    buffer_load_dwordx4 v[64:67], v5, s[8:11], s20 offen
    s_add_u32 s20, s20, 1152
    buffer_load_dwordx4 v[68:71], v5, s[8:11], s20 offen
    s_add_u32 s20, s20, 1152
    buffer_load_dwordx4 v[72:75], v5, s[8:11], s20 offen
    s_add_u32 s20, s20, 1152
    buffer_load_dwordx4 v[76:79], v5, s[8:11], s20 offen
    s_add_u32 s20, s20, 1152
    s_waitcnt vmcnt(2)
    v_perm_b32 v32, v68, v64, s84
    v_perm_b32 v33, v68, v64, s85
    v_perm_b32 v34, v69, v65, s84
    v_perm_b32 v35, v69, v65, s85
    v_dot2c_f32_bf16 v16, v52, v32
    v_dot2c_f32_bf16 v17, v52, v33
    v_dot2c_f32_bf16 v18, v52, v34
    v_dot2c_f32_bf16 v19, v52, v35
    v_perm_b32 v36, v70, v66, s84
    v_perm_b32 v37, v70, v66, s85
    v_perm_b32 v38, v71, v67, s84
    v_perm_b32 v39, v71, v67, s85
    v_dot2c_f32_bf16 v20, v52, v36
    v_dot2c_f32_bf16 v21, v52, v37
    v_dot2c_f32_bf16 v22, v52, v38
    v_dot2c_f32_bf16 v23, v52, v39
    s_waitcnt vmcnt(0)
    v_perm_b32 v32, v76, v72, s84
    v_perm_b32 v33, v76, v72, s85
    v_perm_b32 v34, v77, v73, s84
    v_perm_b32 v35, v77, v73, s85
    v_dot2c_f32_bf16 v16, v53, v32
    v_dot2c_f32_bf16 v17, v53, v33
    v_dot2c_f32_bf16 v18, v53, v34
    v_dot2c_f32_bf16 v19, v53, v35
    v_perm_b32 v36, v78, v74, s84
    v_perm_b32 v37, v78, v74, s85
    v_perm_b32 v38, v79, v75, s84
    v_perm_b32 v39, v79, v75, s85
    v_dot2c_f32_bf16 v20, v53, v36
    v_dot2c_f32_bf16 v21, v53, v37
    v_dot2c_f32_bf16 v22, v53, v38
    v_dot2c_f32_bf16 v23, v53, v39
    buffer_load_dwordx4 v[64:67], v5, s[8:11], s20 offen
    s_add_u32 s20, s20, 1152
    buffer_load_dwordx4 v[68:71], v5, s[8:11], s20 offen
    s_add_u32 s20, s20, 1152
    buffer_load_dwordx4 v[72:75], v5, s[8:11], s20 offen
    s_add_u32 s20, s20, 1152
    buffer_load_dwordx4 v[76:79], v5, s[8:11], s20 offen
    s_add_u32 s20, s20, 1152
    s_waitcnt vmcnt(2)
    v_perm_b32 v32, v68, v64, s84
    v_perm_b32 v33, v68, v64, s85
    v_perm_b32 v34, v69, v65, s84
    v_perm_b32 v35, v69, v65, s85
    v_dot2c_f32_bf16 v16, v54, v32
    v_dot2c_f32_bf16 v17, v54, v33
    v_dot2c_f32_bf16 v18, v54, v34
    v_dot2c_f32_bf16 v19, v54, v35
    v_perm_b32 v36, v70, v66, s84
    v_perm_b32 v37, v70, v66, s85
    v_perm_b32 v38, v71, v67, s84
    v_perm_b32 v39, v71, v67, s85
    v_dot2c_f32_bf16 v20, v54, v36
    v_dot2c_f32_bf16 v21, v54, v37
    v_dot2c_f32_bf16 v22, v54, v38
    v_dot2c_f32_bf16 v23, v54, v39
    s_waitcnt vmcnt(0)
    v_perm_b32 v32, v76, v72, s84
    v_perm_b32 v33, v76, v72, s85
    v_perm_b32 v34, v77, v73, s84
    v_perm_b32 v35, v77, v73, s85
    v_dot2c_f32_bf16 v16, v55, v32
    v_dot2c_f32_bf16 v17, v55, v33
    v_dot2c_f32_bf16 v18, v55, v34
    v_dot2c_f32_bf16 v19, v55, v35
    v_perm_b32 v36, v78, v74, s84
    v_perm_b32 v37, v78, v74, s85
    v_perm_b32 v38, v79, v75, s84
    v_perm_b32 v39, v79, v75, s85
    v_dot2c_f32_bf16 v20, v55, v36
    v_dot2c_f32_bf16 v21, v55, v37
    v_dot2c_f32_bf16 v22, v55, v38
    v_dot2c_f32_bf16 v23, v55, v39
    buffer_load_dwordx4 v[64:67], v5, s[8:11], s20 offen
    s_add_u32 s20, s20, 1152
    buffer_load_dwordx4 v[68:71], v5, s[8:11], s20 offen
    s_add_u32 s20, s20, 1152
    buffer_load_dwordx4 v[72:75], v5, s[8:11], s20 offen
    s_add_u32 s20, s20, 1152
    buffer_load_dwordx4 v[76:79], v5, s[8:11], s20 offen
    s_add_u32 s20, s20, 1152
    s_waitcnt vmcnt(2)
    v_perm_b32 v32, v68, v64, s84
    v_perm_b32 v33, v68, v64, s85
    v_perm_b32 v34, v69, v65, s84
    v_perm_b32 v35, v69, v65, s85
    v_dot2c_f32_bf16 v16, v56, v32
    v_dot2c_f32_bf16 v17, v56, v33
    v_dot2c_f32_bf16 v18, v56, v34
    v_dot2c_f32_bf16 v19, v56, v35
    v_perm_b32 v36, v70, v66, s84
    v_perm_b32 v37, v70, v66, s85
    v_perm_b32 v38, v71, v67, s84
    v_perm_b32 v39, v71, v67, s85
    v_dot2c_f32_bf16 v20, v56, v36
    v_dot2c_f32_bf16 v21, v56, v37
    v_dot2c_f32_bf16 v22, v56, v38
    v_dot2c_f32_bf16 v23, v56, v39
    s_waitcnt vmcnt(0)
    v_perm_b32 v32, v76, v72, s84
    v_perm_b32 v33, v76, v72, s85
    v_perm_b32 v34, v77, v73, s84
    v_perm_b32 v35, v77, v73, s85
    v_dot2c_f32_bf16 v16, v57, v32
    v_dot2c_f32_bf16 v17, v57, v33
    v_dot2c_f32_bf16 v18, v57, v34
    v_dot2c_f32_bf16 v19, v57, v35
    v_perm_b32 v36, v78, v74, s84
    v_perm_b32 v37, v78, v74, s85
    v_perm_b32 v38, v79, v75, s84
    v_perm_b32 v39, v79, v75, s85
    v_dot2c_f32_bf16 v20, v57, v36
    v_dot2c_f32_bf16 v21, v57, v37
    v_dot2c_f32_bf16 v22, v57, v38
    v_dot2c_f32_bf16 v23, v57, v39
    s_mov_b32 s20, 0
    buffer_load_dwordx4 v[64:67], v9, s[8:11], s20 offen
    buffer_load_dwordx4 v[68:71], v9, s[8:11], s20 offen offset:1152
    s_add_u32 s20, s20, 18432
    buffer_load_dwordx4 v[72:75], v9, s[8:11], s20 offen
    buffer_load_dwordx4 v[76:79], v9, s[8:11], s20 offen offset:1152
    s_add_u32 s20, s20, 18432
    buffer_load_dwordx4 v[80:83], v15, s[8:11], s20 offen
    buffer_load_dwordx4 v[84:87], v15, s[8:11], s20 offen offset:1152
    s_add_u32 s20, s20, 18432
    s_waitcnt vmcnt(4)
    v_perm_b32 v32, v68, v64, s84
    v_perm_b32 v33, v68, v64, s85
    v_perm_b32 v34, v69, v65, s84
    v_perm_b32 v35, v69, v65, s85
    v_dot2c_f32_bf16 v24, v58, v32
    v_dot2c_f32_bf16 v25, v58, v33
    v_dot2c_f32_bf16 v26, v58, v34
    v_dot2c_f32_bf16 v27, v58, v35
    v_perm_b32 v36, v70, v66, s84
    v_perm_b32 v37, v70, v66, s85
    v_perm_b32 v38, v71, v67, s84
    v_perm_b32 v39, v71, v67, s85
    v_dot2c_f32_bf16 v28, v58, v36
    v_dot2c_f32_bf16 v29, v58, v37
    v_dot2c_f32_bf16 v30, v58, v38
    v_dot2c_f32_bf16 v31, v58, v39
    s_waitcnt vmcnt(2)
    v_perm_b32 v32, v76, v72, s84
    v_perm_b32 v33, v76, v72, s85
    v_perm_b32 v34, v77, v73, s84
    v_perm_b32 v35, v77, v73, s85
    v_dot2c_f32_bf16 v24, v59, v32
    v_dot2c_f32_bf16 v25, v59, v33
    v_dot2c_f32_bf16 v26, v59, v34
    v_dot2c_f32_bf16 v27, v59, v35
    v_perm_b32 v36, v78, v74, s84
    v_perm_b32 v37, v78, v74, s85
    v_perm_b32 v38, v79, v75, s84
    v_perm_b32 v39, v79, v75, s85
    v_dot2c_f32_bf16 v28, v59, v36
    v_dot2c_f32_bf16 v29, v59, v37
    v_dot2c_f32_bf16 v30, v59, v38
    v_dot2c_f32_bf16 v31, v59, v39
    s_waitcnt vmcnt(0)
    v_perm_b32 v32, v84, v80, s84
    v_perm_b32 v33, v84, v80, s85
    v_perm_b32 v34, v85, v81, s84
    v_perm_b32 v35, v85, v81, s85
    v_dot2c_f32_bf16 v24, v60, v32
    v_dot2c_f32_bf16 v25, v60, v33
    v_dot2c_f32_bf16 v26, v60, v34
    v_dot2c_f32_bf16 v27, v60, v35
    v_perm_b32 v36, v86, v82, s84
    v_perm_b32 v37, v86, v82, s85
    v_perm_b32 v38, v87, v83, s84
    v_perm_b32 v39, v87, v83, s85
    v_dot2c_f32_bf16 v28, v60, v36
    v_dot2c_f32_bf16 v29, v60, v37
    v_dot2c_f32_bf16 v30, v60, v38
    v_dot2c_f32_bf16 v31, v60, v39
    v_mul_f32 v16, v16, v13
    v_mul_f32 v24, v24, v13
    v_mul_f32 v17, v17, v13
    v_mul_f32 v25, v25, v13
    v_mul_f32 v18, v18, v13
    v_mul_f32 v26, v26, v13
    v_mul_f32 v19, v19, v13
    v_mul_f32 v27, v27, v13
    v_mul_f32 v20, v20, v13
    v_mul_f32 v28, v28, v13
    v_mul_f32 v21, v21, v13
    v_mul_f32 v29, v29, v13
    v_mul_f32 v22, v22, v13
    v_mul_f32 v30, v30, v13
    v_mul_f32 v23, v23, v13
    v_mul_f32 v31, v31, v13
    s_mul_i32 s20, s65, 147456
    s_add_u32 s8, s44, s20
    s_addc_u32 s9, s45, 0
    s_mov_b32 s10, 147456
    s_mov_b32 s11, 0x20000
    s_lshl_b32 s20, s67, 8
    v_lshlrev_b32 v5, 4, v3
    v_add_u32 v5, s20, v5
    v_mul_u32_u24 v6, 36864, v2
    v_add_u32 v5, v5, v6
    s_mul_i32 s20, s67, 36864
    v_add_u32 v9, s20, v14
    s_mov_b32 s20, 0
    buffer_load_dwordx4 v[64:67], v5, s[8:11], s20 offen
    s_add_u32 s20, s20, 1152
    buffer_load_dwordx4 v[68:71], v5, s[8:11], s20 offen
    s_add_u32 s20, s20, 1152
    buffer_load_dwordx4 v[72:75], v5, s[8:11], s20 offen
    s_add_u32 s20, s20, 1152
    buffer_load_dwordx4 v[76:79], v5, s[8:11], s20 offen
    s_add_u32 s20, s20, 1152
    s_waitcnt vmcnt(2)
    v_perm_b32 v208, v68, v64, s84
    v_perm_b32 v209, v69, v65, s84
    v_perm_b32 v210, v70, v66, s84
    v_perm_b32 v211, v71, v67, s84
    v_perm_b32 v68, v68, v64, s85
    v_perm_b32 v69, v69, v65, s85
    v_perm_b32 v70, v70, v66, s85
    v_perm_b32 v71, v71, v67, s85
    s_waitcnt vmcnt(0)
    v_perm_b32 v64, v76, v72, s84
    v_perm_b32 v65, v77, v73, s84
    v_perm_b32 v66, v78, v74, s84
    v_perm_b32 v67, v79, v75, s84
    v_perm_b32 v76, v76, v72, s85
    v_perm_b32 v77, v77, v73, s85
    v_perm_b32 v78, v78, v74, s85
    v_perm_b32 v79, v79, v75, s85
    buffer_load_dwordx4 v[80:83], v5, s[8:11], s20 offen
    s_add_u32 s20, s20, 1152
    buffer_load_dwordx4 v[84:87], v5, s[8:11], s20 offen
    s_add_u32 s20, s20, 1152
    buffer_load_dwordx4 v[88:91], v5, s[8:11], s20 offen
    s_add_u32 s20, s20, 1152
    buffer_load_dwordx4 v[92:95], v5, s[8:11], s20 offen
    s_add_u32 s20, s20, 1152
    s_waitcnt vmcnt(2)
    v_perm_b32 v72, v84, v80, s84
    v_perm_b32 v73, v85, v81, s84
    v_perm_b32 v74, v86, v82, s84
    v_perm_b32 v75, v87, v83, s84
    v_perm_b32 v84, v84, v80, s85
    v_perm_b32 v85, v85, v81, s85
    v_perm_b32 v86, v86, v82, s85
    v_perm_b32 v87, v87, v83, s85
    s_waitcnt vmcnt(0)
    v_perm_b32 v80, v92, v88, s84
    v_perm_b32 v81, v93, v89, s84
    v_perm_b32 v82, v94, v90, s84
    v_perm_b32 v83, v95, v91, s84
    v_perm_b32 v92, v92, v88, s85
    v_perm_b32 v93, v93, v89, s85
    v_perm_b32 v94, v94, v90, s85
    v_perm_b32 v95, v95, v91, s85
    buffer_load_dwordx4 v[96:99], v5, s[8:11], s20 offen
    s_add_u32 s20, s20, 1152
    buffer_load_dwordx4 v[100:103], v5, s[8:11], s20 offen
    s_add_u32 s20, s20, 1152
    buffer_load_dwordx4 v[104:107], v5, s[8:11], s20 offen
    s_add_u32 s20, s20, 1152
    buffer_load_dwordx4 v[108:111], v5, s[8:11], s20 offen
    s_add_u32 s20, s20, 1152
    s_waitcnt vmcnt(2)
    v_perm_b32 v88, v100, v96, s84
    v_perm_b32 v89, v101, v97, s84
    v_perm_b32 v90, v102, v98, s84
    v_perm_b32 v91, v103, v99, s84
    v_perm_b32 v100, v100, v96, s85
    v_perm_b32 v101, v101, v97, s85
    v_perm_b32 v102, v102, v98, s85
    v_perm_b32 v103, v103, v99, s85
    s_waitcnt vmcnt(0)
    v_perm_b32 v96, v108, v104, s84
    v_perm_b32 v97, v109, v105, s84
    v_perm_b32 v98, v110, v106, s84
    v_perm_b32 v99, v111, v107, s84
    v_perm_b32 v108, v108, v104, s85
    v_perm_b32 v109, v109, v105, s85
    v_perm_b32 v110, v110, v106, s85
    v_perm_b32 v111, v111, v107, s85
    buffer_load_dwordx4 v[112:115], v5, s[8:11], s20 offen
    s_add_u32 s20, s20, 1152
    buffer_load_dwordx4 v[116:119], v5, s[8:11], s20 offen
    s_add_u32 s20, s20, 1152
    buffer_load_dwordx4 v[120:123], v5, s[8:11], s20 offen
    s_add_u32 s20, s20, 1152
    buffer_load_dwordx4 v[124:127], v5, s[8:11], s20 offen
    s_add_u32 s20, s20, 1152
    s_waitcnt vmcnt(2)
    v_perm_b32 v104, v116, v112, s84
    v_perm_b32 v105, v117, v113, s84
    v_perm_b32 v106, v118, v114, s84
    v_perm_b32 v107, v119, v115, s84
    v_perm_b32 v116, v116, v112, s85
    v_perm_b32 v117, v117, v113, s85
    v_perm_b32 v118, v118, v114, s85
    v_perm_b32 v119, v119, v115, s85
    s_waitcnt vmcnt(0)
    v_perm_b32 v112, v124, v120, s84
    v_perm_b32 v113, v125, v121, s84
    v_perm_b32 v114, v126, v122, s84
    v_perm_b32 v115, v127, v123, s84
    v_perm_b32 v124, v124, v120, s85
    v_perm_b32 v125, v125, v121, s85
    v_perm_b32 v126, v126, v122, s85
    v_perm_b32 v127, v127, v123, s85
    buffer_load_dwordx4 v[128:131], v5, s[8:11], s20 offen
    s_add_u32 s20, s20, 1152
    buffer_load_dwordx4 v[132:135], v5, s[8:11], s20 offen
    s_add_u32 s20, s20, 1152
    buffer_load_dwordx4 v[136:139], v5, s[8:11], s20 offen
    s_add_u32 s20, s20, 1152
    buffer_load_dwordx4 v[140:143], v5, s[8:11], s20 offen
    s_add_u32 s20, s20, 1152
    s_waitcnt vmcnt(2)
    v_perm_b32 v120, v132, v128, s84
    v_perm_b32 v121, v133, v129, s84
    v_perm_b32 v122, v134, v130, s84
    v_perm_b32 v123, v135, v131, s84
    v_perm_b32 v132, v132, v128, s85
    v_perm_b32 v133, v133, v129, s85
    v_perm_b32 v134, v134, v130, s85
    v_perm_b32 v135, v135, v131, s85
    s_waitcnt vmcnt(0)
    v_perm_b32 v128, v140, v136, s84
    v_perm_b32 v129, v141, v137, s84
    v_perm_b32 v130, v142, v138, s84
    v_perm_b32 v131, v143, v139, s84
    v_perm_b32 v140, v140, v136, s85
    v_perm_b32 v141, v141, v137, s85
    v_perm_b32 v142, v142, v138, s85
    v_perm_b32 v143, v143, v139, s85
    buffer_load_dwordx4 v[144:147], v5, s[8:11], s20 offen
    s_add_u32 s20, s20, 1152
    buffer_load_dwordx4 v[148:151], v5, s[8:11], s20 offen
    s_add_u32 s20, s20, 1152
    buffer_load_dwordx4 v[152:155], v5, s[8:11], s20 offen
    s_add_u32 s20, s20, 1152
    buffer_load_dwordx4 v[156:159], v5, s[8:11], s20 offen
    s_add_u32 s20, s20, 1152
    s_waitcnt vmcnt(2)
    v_perm_b32 v136, v148, v144, s84
    v_perm_b32 v137, v149, v145, s84
    v_perm_b32 v138, v150, v146, s84
    v_perm_b32 v139, v151, v147, s84
    v_perm_b32 v148, v148, v144, s85
    v_perm_b32 v149, v149, v145, s85
    v_perm_b32 v150, v150, v146, s85
    v_perm_b32 v151, v151, v147, s85
    s_waitcnt vmcnt(0)
    v_perm_b32 v144, v156, v152, s84
    v_perm_b32 v145, v157, v153, s84
    v_perm_b32 v146, v158, v154, s84
    v_perm_b32 v147, v159, v155, s84
    v_perm_b32 v156, v156, v152, s85
    v_perm_b32 v157, v157, v153, s85
    v_perm_b32 v158, v158, v154, s85
    v_perm_b32 v159, v159, v155, s85
    buffer_load_dwordx4 v[160:163], v5, s[8:11], s20 offen
    s_add_u32 s20, s20, 1152
    buffer_load_dwordx4 v[164:167], v5, s[8:11], s20 offen
    s_add_u32 s20, s20, 1152
    buffer_load_dwordx4 v[168:171], v5, s[8:11], s20 offen
    s_add_u32 s20, s20, 1152
    buffer_load_dwordx4 v[172:175], v5, s[8:11], s20 offen
    s_add_u32 s20, s20, 1152
    s_waitcnt vmcnt(2)
    v_perm_b32 v152, v164, v160, s84
    v_perm_b32 v153, v165, v161, s84
    v_perm_b32 v154, v166, v162, s84
    v_perm_b32 v155, v167, v163, s84
    v_perm_b32 v164, v164, v160, s85
    v_perm_b32 v165, v165, v161, s85
    v_perm_b32 v166, v166, v162, s85
    v_perm_b32 v167, v167, v163, s85
    s_waitcnt vmcnt(0)
    v_perm_b32 v160, v172, v168, s84
    v_perm_b32 v161, v173, v169, s84
    v_perm_b32 v162, v174, v170, s84
    v_perm_b32 v163, v175, v171, s84
    v_perm_b32 v172, v172, v168, s85
    v_perm_b32 v173, v173, v169, s85
    v_perm_b32 v174, v174, v170, s85
    v_perm_b32 v175, v175, v171, s85
    buffer_load_dwordx4 v[176:179], v5, s[8:11], s20 offen
    s_add_u32 s20, s20, 1152
    buffer_load_dwordx4 v[180:183], v5, s[8:11], s20 offen
    s_add_u32 s20, s20, 1152
    buffer_load_dwordx4 v[184:187], v5, s[8:11], s20 offen
    s_add_u32 s20, s20, 1152
    buffer_load_dwordx4 v[188:191], v5, s[8:11], s20 offen
    s_add_u32 s20, s20, 1152
    s_waitcnt vmcnt(2)
    v_perm_b32 v168, v180, v176, s84
    v_perm_b32 v169, v181, v177, s84
    v_perm_b32 v170, v182, v178, s84
    v_perm_b32 v171, v183, v179, s84
    v_perm_b32 v180, v180, v176, s85
    v_perm_b32 v181, v181, v177, s85
    v_perm_b32 v182, v182, v178, s85
    v_perm_b32 v183, v183, v179, s85
    s_waitcnt vmcnt(0)
    v_perm_b32 v176, v188, v184, s84
    v_perm_b32 v177, v189, v185, s84
    v_perm_b32 v178, v190, v186, s84
    v_perm_b32 v179, v191, v187, s84
    v_perm_b32 v188, v188, v184, s85
    v_perm_b32 v189, v189, v185, s85
    v_perm_b32 v190, v190, v186, s85
    v_perm_b32 v191, v191, v187, s85
    s_mov_b32 s20, 0
    buffer_load_dwordx4 v[192:195], v9, s[8:11], s20 offen
    buffer_load_dwordx4 v[196:199], v9, s[8:11], s20 offen offset:1152
    s_add_u32 s20, s20, 18432
    buffer_load_dwordx4 v[200:203], v9, s[8:11], s20 offen
    buffer_load_dwordx4 v[204:207], v9, s[8:11], s20 offen offset:1152
    s_add_u32 s20, s20, 18432
    s_waitcnt vmcnt(2)
    v_perm_b32 v184, v196, v192, s84
    v_perm_b32 v185, v197, v193, s84
    v_perm_b32 v186, v198, v194, s84
    v_perm_b32 v187, v199, v195, s84
    v_perm_b32 v196, v196, v192, s85
    v_perm_b32 v197, v197, v193, s85
    v_perm_b32 v198, v198, v194, s85
    v_perm_b32 v199, v199, v195, s85
    s_waitcnt vmcnt(0)
    v_perm_b32 v192, v204, v200, s84
    v_perm_b32 v193, v205, v201, s84
    v_perm_b32 v194, v206, v202, s84
    v_perm_b32 v195, v207, v203, s84
    v_perm_b32 v204, v204, v200, s85
    v_perm_b32 v205, v205, v201, s85
    v_perm_b32 v206, v206, v202, s85
    v_perm_b32 v207, v207, v203, s85
    v_lshlrev_b32 v2, 3, v0
    v_mov_b32 v3, 0
    v_and_b32 v4, 15, v0
    v_lshlrev_b32 v4, 5, v4
    v_lshrrev_b32 v5, 4, v0
    v_lshrrev_b32 v6, 5, v0
    v_lshl_add_u32 v4, v6, 4, v4
    s_lshl_b32 s20, s67, 9
    v_add_u32 v4, s20, v4
    v_and_b32 v6, 16, v0
    v_mov_b32 v9, 2.0
    v_cmp_eq_u32 vcc, 0, v6
    s_nop 1
    v_cndmask_b32 v4, v9, v4, vcc
    s_lshl_b32 s20, s67, 6
    v_lshlrev_b32 v6, 2, v7
    v_add_u32 v6, s20, v6
    v_add_u32 v9, 32, v6
    s_lshl_b32 s20, s67, 8
    v_lshlrev_b32 v13, 5, v8
    v_lshl_add_u32 v13, v5, 3, v13
    v_add_u32 v13, s20, v13
    s_mul_i32 s20, s88, 2304
    s_add_u32 s16, s62, s20
    s_addc_u32 s17, s63, 0
    s_mov_b32 s18, 2304
    s_mov_b32 s19, 0x20000
    v_lshrrev_b32 v7, 3, v0
    v_and_b32 v8, 7, v0
    v_mul_u32_u24 v244, 2304, v7
    v_lshl_add_u32 v244, v8, 4, v244
    v_lshlrev_b32 v245, 3, v8
    v_lshl_add_u32 v245, v5, 1, v245
    s_mul_i32 s20, s64, 73728
    s_add_u32 s12, s62, s20
    s_addc_u32 s13, s63, 0
    s_mov_b32 s14, 73728
    s_mov_b32 s15, 0x20000
    s_add_u32 s4, s58, s21
    s_addc_u32 s5, s59, 0
    s_mov_b32 s6, 1152
    s_mov_b32 s7, 0x20000
    buffer_load_dword v15, v3, s[4:7], 0 offen
    buffer_load_dword v14, v3, s[16:19], 0 offen sc1
    buffer_load_dword v32, v3, s[28:31], 0 offen sc1
    s_waitcnt vmcnt(0)
    s_mov_b32 s26, 0
    v_mov_b32 v14, 1
    v_mov_b32 v15, 0
    s_barrier
    s_cmp_lg_u32 s67, 0
    s_cbranch_scc1 L_noticket
    s_mov_b64 exec, 1
    buffer_atomic_add v14, v15, s[28:31], 0 offen sc0
    s_mov_b64 exec, -1
L_noticket:
    ds_read_b128 v[40:43], v3 offset:9344
    ds_read_b128 v[44:47], v3 offset:9360
    s_waitcnt lgkmcnt(0)
    v_max3_f32 v32, v40, v42, v44
    v_max_f32 v32, v32, v46
    v_sub_f32 v40, v40, v32
    v_sub_f32 v42, v42, v32
    v_sub_f32 v44, v44, v32
    v_sub_f32 v46, v46, v32
    v_exp_f32 v40, v40
    v_exp_f32 v42, v42
    v_exp_f32 v44, v44
    v_exp_f32 v46, v46
    v_mul_f32 v32, v40, v41
    v_fmac_f32 v32, v42, v43
    v_fmac_f32 v32, v44, v45
    v_fmac_f32 v32, v46, v47
    v_rcp_f32 v32, v32
    s_nop 0
    v_mul_f32 v32, v32, v12
    v_mul_f32 v40, v40, v32
    v_mul_f32 v42, v42, v32
    v_mul_f32 v44, v44, v32
    v_mul_f32 v46, v46, v32
    s_cmp_lg_u32 s67, 0
    s_cbranch_scc1 L_noticket2
    s_waitcnt vmcnt(0)
    v_readfirstlane_b32 s22, v14
L_clrwait:
    s_and_b32 s23, s22, 0xffff
    s_cmp_lt_u32 s23, 27
    s_cbranch_scc1 L_clrok
    s_cmp_ge_u32 s22, 0x200000
    s_cbranch_scc1 L_clrok
    s_sleep 8
    buffer_load_dword v14, v15, s[28:31], 0 offen sc1
    s_waitcnt vmcnt(0)
    v_readfirstlane_b32 s20, v14
    s_and_b32 s20, s20, 0xffff0000
    s_or_b32 s22, s20, s23
    s_branch L_clrwait
L_clrok:
    v_mov_b32 v14, s23
    ds_write_b32 v3, v14 offset:9380
    s_waitcnt lgkmcnt(0)
L_noticket2:
    s_barrier
L_tail:
    ds_read_b32 v14, v3 offset:9380
    ds_read_b64 v[48:49], v2 offset:9408
    ds_read_b64 v[50:51], v2 offset:9920
    ds_read_b64 v[52:53], v2 offset:10432
    ds_read_b64 v[54:55], v2 offset:10944
    s_waitcnt lgkmcnt(0)
    v_mul_f32 v32, v40, v48
    v_mul_f32 v33, v40, v49
    v_fmac_f32 v32, v42, v50
    v_fmac_f32 v33, v42, v51
    v_fmac_f32 v32, v44, v52
    v_fmac_f32 v33, v44, v53
    v_fmac_f32 v32, v46, v54
    v_fmac_f32 v33, v46, v55
    v_readfirstlane_b32 s23, v14
    v_cvt_pk_bf16_f32 v34, v32, v33
    s_sub_u32 s24, s23, 27
    s_lshl_b32 s24, s24, 2
    s_add_u32 s24, s24, s67
    s_cmp_lt_u32 s23, 27
    s_cselect_b32 s24, 99, s24
    s_cmp_ge_u32 s24, 18
    s_cbranch_scc1 L_notred1
    s_lshl_b32 s25, s24, 7
    s_add_u32 s33, s25, 18432
    s_add_u32 s34, s25, 36864
    s_add_u32 s35, s25, 55296
    buffer_load_dwordx4 v[212:215], v244, s[12:15], s25 offen sc1
    buffer_load_dwordx4 v[216:219], v244, s[12:15], s33 offen sc1
    buffer_load_dwordx4 v[220:223], v244, s[12:15], s34 offen sc1
    buffer_load_dwordx4 v[224:227], v244, s[12:15], s35 offen sc1
L_notred1:
    ds_bpermute_b32 v48, v6, v34
    ds_bpermute_b32 v49, v9, v34
    v_dot2c_f32_bf16_dpp v16, v34, v208 row_newbcast:0 row_mask:0xf bank_mask:0xf
    v_dot2c_f32_bf16_dpp v17, v34, v68 row_newbcast:0 row_mask:0xf bank_mask:0xf
    v_dot2c_f32_bf16_dpp v18, v34, v209 row_newbcast:0 row_mask:0xf bank_mask:0xf
    v_dot2c_f32_bf16_dpp v19, v34, v69 row_newbcast:0 row_mask:0xf bank_mask:0xf
    v_dot2c_f32_bf16_dpp v20, v34, v210 row_newbcast:0 row_mask:0xf bank_mask:0xf
    v_dot2c_f32_bf16_dpp v21, v34, v70 row_newbcast:0 row_mask:0xf bank_mask:0xf
    v_dot2c_f32_bf16_dpp v22, v34, v211 row_newbcast:0 row_mask:0xf bank_mask:0xf
    v_dot2c_f32_bf16_dpp v23, v34, v71 row_newbcast:0 row_mask:0xf bank_mask:0xf
    v_dot2c_f32_bf16_dpp v16, v34, v64 row_newbcast:1 row_mask:0xf bank_mask:0xf
    v_dot2c_f32_bf16_dpp v17, v34, v76 row_newbcast:1 row_mask:0xf bank_mask:0xf
    v_dot2c_f32_bf16_dpp v18, v34, v65 row_newbcast:1 row_mask:0xf bank_mask:0xf
    v_dot2c_f32_bf16_dpp v19, v34, v77 row_newbcast:1 row_mask:0xf bank_mask:0xf
    v_dot2c_f32_bf16_dpp v20, v34, v66 row_newbcast:1 row_mask:0xf bank_mask:0xf
    v_dot2c_f32_bf16_dpp v21, v34, v78 row_newbcast:1 row_mask:0xf bank_mask:0xf
    v_dot2c_f32_bf16_dpp v22, v34, v67 row_newbcast:1 row_mask:0xf bank_mask:0xf
    v_dot2c_f32_bf16_dpp v23, v34, v79 row_newbcast:1 row_mask:0xf bank_mask:0xf
    v_dot2c_f32_bf16_dpp v16, v34, v72 row_newbcast:2 row_mask:0xf bank_mask:0xf
    v_dot2c_f32_bf16_dpp v17, v34, v84 row_newbcast:2 row_mask:0xf bank_mask:0xf
    s_waitcnt lgkmcnt(0)
    v_dot2c_f32_bf16_dpp v18, v34, v73 row_newbcast:2 row_mask:0xf bank_mask:0xf
    v_dot2c_f32_bf16_dpp v19, v34, v85 row_newbcast:2 row_mask:0xf bank_mask:0xf
    v_dot2c_f32_bf16 v24, v48, v184
    v_dot2c_f32_bf16_dpp v20, v34, v74 row_newbcast:2 row_mask:0xf bank_mask:0xf
    v_dot2c_f32_bf16_dpp v21, v34, v86 row_newbcast:2 row_mask:0xf bank_mask:0xf
    v_dot2c_f32_bf16 v25, v48, v196
    v_dot2c_f32_bf16_dpp v22, v34, v75 row_newbcast:2 row_mask:0xf bank_mask:0xf
    v_dot2c_f32_bf16_dpp v23, v34, v87 row_newbcast:2 row_mask:0xf bank_mask:0xf
    v_dot2c_f32_bf16 v26, v48, v185
    v_dot2c_f32_bf16_dpp v16, v34, v80 row_newbcast:3 row_mask:0xf bank_mask:0xf
    v_dot2c_f32_bf16_dpp v17, v34, v92 row_newbcast:3 row_mask:0xf bank_mask:0xf
    v_dot2c_f32_bf16 v27, v48, v197
    v_dot2c_f32_bf16_dpp v18, v34, v81 row_newbcast:3 row_mask:0xf bank_mask:0xf
    v_dot2c_f32_bf16_dpp v19, v34, v93 row_newbcast:3 row_mask:0xf bank_mask:0xf
    v_dot2c_f32_bf16 v28, v48, v186
    v_dot2c_f32_bf16_dpp v20, v34, v82 row_newbcast:3 row_mask:0xf bank_mask:0xf
    v_dot2c_f32_bf16_dpp v21, v34, v94 row_newbcast:3 row_mask:0xf bank_mask:0xf
    v_dot2c_f32_bf16 v29, v48, v198
    v_dot2c_f32_bf16_dpp v22, v34, v83 row_newbcast:3 row_mask:0xf bank_mask:0xf
    v_dot2c_f32_bf16_dpp v23, v34, v95 row_newbcast:3 row_mask:0xf bank_mask:0xf
    v_dot2c_f32_bf16 v30, v48, v187
    v_dot2c_f32_bf16_dpp v16, v34, v88 row_newbcast:4 row_mask:0xf bank_mask:0xf
    v_dot2c_f32_bf16_dpp v17, v34, v100 row_newbcast:4 row_mask:0xf bank_mask:0xf
    v_dot2c_f32_bf16 v31, v48, v199
    v_dot2c_f32_bf16_dpp v18, v34, v89 row_newbcast:4 row_mask:0xf bank_mask:0xf
    v_dot2c_f32_bf16_dpp v19, v34, v101 row_newbcast:4 row_mask:0xf bank_mask:0xf
    v_dot2c_f32_bf16 v24, v49, v192
    v_dot2c_f32_bf16_dpp v20, v34, v90 row_newbcast:4 row_mask:0xf bank_mask:0xf
    v_dot2c_f32_bf16_dpp v21, v34, v102 row_newbcast:4 row_mask:0xf bank_mask:0xf
    v_dot2c_f32_bf16 v25, v49, v204
    v_dot2c_f32_bf16_dpp v22, v34, v91 row_newbcast:4 row_mask:0xf bank_mask:0xf
    v_dot2c_f32_bf16_dpp v23, v34, v103 row_newbcast:4 row_mask:0xf bank_mask:0xf
    v_dot2c_f32_bf16 v26, v49, v193
    v_dot2c_f32_bf16_dpp v16, v34, v96 row_newbcast:5 row_mask:0xf bank_mask:0xf
    v_dot2c_f32_bf16_dpp v17, v34, v108 row_newbcast:5 row_mask:0xf bank_mask:0xf
    v_dot2c_f32_bf16 v27, v49, v205
    v_dot2c_f32_bf16_dpp v18, v34, v97 row_newbcast:5 row_mask:0xf bank_mask:0xf
    v_dot2c_f32_bf16_dpp v19, v34, v109 row_newbcast:5 row_mask:0xf bank_mask:0xf
    v_dot2c_f32_bf16 v28, v49, v194
    v_dot2c_f32_bf16_dpp v20, v34, v98 row_newbcast:5 row_mask:0xf bank_mask:0xf
    v_dot2c_f32_bf16_dpp v21, v34, v110 row_newbcast:5 row_mask:0xf bank_mask:0xf
    v_dot2c_f32_bf16 v29, v49, v206
    v_dot2c_f32_bf16_dpp v22, v34, v99 row_newbcast:5 row_mask:0xf bank_mask:0xf
    v_dot2c_f32_bf16_dpp v23, v34, v111 row_newbcast:5 row_mask:0xf bank_mask:0xf
    v_dot2c_f32_bf16 v30, v49, v195
    v_dot2c_f32_bf16_dpp v16, v34, v104 row_newbcast:6 row_mask:0xf bank_mask:0xf
    v_dot2c_f32_bf16_dpp v17, v34, v116 row_newbcast:6 row_mask:0xf bank_mask:0xf
    v_dot2c_f32_bf16 v31, v49, v207
    v_dot2c_f32_bf16_dpp v18, v34, v105 row_newbcast:6 row_mask:0xf bank_mask:0xf
    v_dot2c_f32_bf16_dpp v19, v34, v117 row_newbcast:6 row_mask:0xf bank_mask:0xf
    v_permlane32_swap_b32 v24, v28
    v_dot2c_f32_bf16_dpp v20, v34, v106 row_newbcast:6 row_mask:0xf bank_mask:0xf
    v_dot2c_f32_bf16_dpp v21, v34, v118 row_newbcast:6 row_mask:0xf bank_mask:0xf
    v_permlane32_swap_b32 v25, v29
    v_dot2c_f32_bf16_dpp v22, v34, v107 row_newbcast:6 row_mask:0xf bank_mask:0xf
    v_dot2c_f32_bf16_dpp v23, v34, v119 row_newbcast:6 row_mask:0xf bank_mask:0xf
    v_permlane32_swap_b32 v26, v30
    v_dot2c_f32_bf16_dpp v16, v34, v112 row_newbcast:7 row_mask:0xf bank_mask:0xf
    v_dot2c_f32_bf16_dpp v17, v34, v124 row_newbcast:7 row_mask:0xf bank_mask:0xf
    v_permlane32_swap_b32 v27, v31
    v_dot2c_f32_bf16_dpp v18, v34, v113 row_newbcast:7 row_mask:0xf bank_mask:0xf
    v_dot2c_f32_bf16_dpp v19, v34, v125 row_newbcast:7 row_mask:0xf bank_mask:0xf
    v_add_f32 v24, v24, v28
    v_dot2c_f32_bf16_dpp v20, v34, v114 row_newbcast:7 row_mask:0xf bank_mask:0xf
    v_dot2c_f32_bf16_dpp v21, v34, v126 row_newbcast:7 row_mask:0xf bank_mask:0xf
    v_add_f32 v25, v25, v29
    v_dot2c_f32_bf16_dpp v22, v34, v115 row_newbcast:7 row_mask:0xf bank_mask:0xf
    v_dot2c_f32_bf16_dpp v23, v34, v127 row_newbcast:7 row_mask:0xf bank_mask:0xf
    v_add_f32 v26, v26, v30
    v_dot2c_f32_bf16_dpp v16, v34, v120 row_newbcast:8 row_mask:0xf bank_mask:0xf
    v_dot2c_f32_bf16_dpp v17, v34, v132 row_newbcast:8 row_mask:0xf bank_mask:0xf
    v_add_f32 v27, v27, v31
    v_dot2c_f32_bf16_dpp v18, v34, v121 row_newbcast:8 row_mask:0xf bank_mask:0xf
    v_dot2c_f32_bf16_dpp v19, v34, v133 row_newbcast:8 row_mask:0xf bank_mask:0xf
    v_permlane16_swap_b32 v24, v26
    v_dot2c_f32_bf16_dpp v20, v34, v122 row_newbcast:8 row_mask:0xf bank_mask:0xf
    v_dot2c_f32_bf16_dpp v21, v34, v134 row_newbcast:8 row_mask:0xf bank_mask:0xf
    v_permlane16_swap_b32 v25, v27
    v_dot2c_f32_bf16_dpp v22, v34, v123 row_newbcast:8 row_mask:0xf bank_mask:0xf
    v_dot2c_f32_bf16_dpp v23, v34, v135 row_newbcast:8 row_mask:0xf bank_mask:0xf
    v_add_f32 v24, v24, v26
    v_dot2c_f32_bf16_dpp v16, v34, v128 row_newbcast:9 row_mask:0xf bank_mask:0xf
    v_dot2c_f32_bf16_dpp v17, v34, v140 row_newbcast:9 row_mask:0xf bank_mask:0xf
    v_add_f32 v25, v25, v27
    v_dot2c_f32_bf16_dpp v18, v34, v129 row_newbcast:9 row_mask:0xf bank_mask:0xf
    v_dot2c_f32_bf16_dpp v19, v34, v141 row_newbcast:9 row_mask:0xf bank_mask:0xf
    v_add_f32_dpp v24, v24, v24 row_ror:8 row_mask:0xf bank_mask:0xf
    v_dot2c_f32_bf16_dpp v20, v34, v130 row_newbcast:9 row_mask:0xf bank_mask:0xf
    v_dot2c_f32_bf16_dpp v21, v34, v142 row_newbcast:9 row_mask:0xf bank_mask:0xf
    v_add_f32_dpp v25, v25, v25 row_ror:8 row_mask:0xf bank_mask:0xf
    v_dot2c_f32_bf16_dpp v22, v34, v131 row_newbcast:9 row_mask:0xf bank_mask:0xf
    v_dot2c_f32_bf16_dpp v23, v34, v143 row_newbcast:9 row_mask:0xf bank_mask:0xf
    ds_write_b64 v13, v[24:25] offset:11456
    v_dot2c_f32_bf16_dpp v16, v34, v136 row_newbcast:10 row_mask:0xf bank_mask:0xf
    v_dot2c_f32_bf16_dpp v17, v34, v148 row_newbcast:10 row_mask:0xf bank_mask:0xf
    v_dot2c_f32_bf16_dpp v18, v34, v137 row_newbcast:10 row_mask:0xf bank_mask:0xf
    v_dot2c_f32_bf16_dpp v19, v34, v149 row_newbcast:10 row_mask:0xf bank_mask:0xf
    v_dot2c_f32_bf16_dpp v20, v34, v138 row_newbcast:10 row_mask:0xf bank_mask:0xf
    v_dot2c_f32_bf16_dpp v21, v34, v150 row_newbcast:10 row_mask:0xf bank_mask:0xf
    v_dot2c_f32_bf16_dpp v22, v34, v139 row_newbcast:10 row_mask:0xf bank_mask:0xf
    v_dot2c_f32_bf16_dpp v23, v34, v151 row_newbcast:10 row_mask:0xf bank_mask:0xf
    s_waitcnt lgkmcnt(0)
    v_dot2c_f32_bf16_dpp v16, v34, v144 row_newbcast:11 row_mask:0xf bank_mask:0xf
    v_dot2c_f32_bf16_dpp v17, v34, v156 row_newbcast:11 row_mask:0xf bank_mask:0xf
    s_barrier
    v_dot2c_f32_bf16_dpp v18, v34, v145 row_newbcast:11 row_mask:0xf bank_mask:0xf
    v_dot2c_f32_bf16_dpp v19, v34, v157 row_newbcast:11 row_mask:0xf bank_mask:0xf
    v_dot2c_f32_bf16_dpp v20, v34, v146 row_newbcast:11 row_mask:0xf bank_mask:0xf
    v_dot2c_f32_bf16_dpp v21, v34, v158 row_newbcast:11 row_mask:0xf bank_mask:0xf
    v_dot2c_f32_bf16_dpp v22, v34, v147 row_newbcast:11 row_mask:0xf bank_mask:0xf
    v_dot2c_f32_bf16_dpp v23, v34, v159 row_newbcast:11 row_mask:0xf bank_mask:0xf
    v_dot2c_f32_bf16_dpp v16, v34, v152 row_newbcast:12 row_mask:0xf bank_mask:0xf
    v_dot2c_f32_bf16_dpp v17, v34, v164 row_newbcast:12 row_mask:0xf bank_mask:0xf
    v_dot2c_f32_bf16_dpp v18, v34, v153 row_newbcast:12 row_mask:0xf bank_mask:0xf
    v_dot2c_f32_bf16_dpp v19, v34, v165 row_newbcast:12 row_mask:0xf bank_mask:0xf
    v_dot2c_f32_bf16_dpp v20, v34, v154 row_newbcast:12 row_mask:0xf bank_mask:0xf
    v_dot2c_f32_bf16_dpp v21, v34, v166 row_newbcast:12 row_mask:0xf bank_mask:0xf
    v_dot2c_f32_bf16_dpp v22, v34, v155 row_newbcast:12 row_mask:0xf bank_mask:0xf
    v_dot2c_f32_bf16_dpp v23, v34, v167 row_newbcast:12 row_mask:0xf bank_mask:0xf
    v_dot2c_f32_bf16_dpp v16, v34, v160 row_newbcast:13 row_mask:0xf bank_mask:0xf
    v_dot2c_f32_bf16_dpp v17, v34, v172 row_newbcast:13 row_mask:0xf bank_mask:0xf
    v_dot2c_f32_bf16_dpp v18, v34, v161 row_newbcast:13 row_mask:0xf bank_mask:0xf
    v_dot2c_f32_bf16_dpp v19, v34, v173 row_newbcast:13 row_mask:0xf bank_mask:0xf
    v_dot2c_f32_bf16_dpp v20, v34, v162 row_newbcast:13 row_mask:0xf bank_mask:0xf
    v_dot2c_f32_bf16_dpp v21, v34, v174 row_newbcast:13 row_mask:0xf bank_mask:0xf
    v_dot2c_f32_bf16_dpp v22, v34, v163 row_newbcast:13 row_mask:0xf bank_mask:0xf
    v_dot2c_f32_bf16_dpp v23, v34, v175 row_newbcast:13 row_mask:0xf bank_mask:0xf
    v_dot2c_f32_bf16_dpp v16, v34, v168 row_newbcast:14 row_mask:0xf bank_mask:0xf
    v_dot2c_f32_bf16_dpp v17, v34, v180 row_newbcast:14 row_mask:0xf bank_mask:0xf
    v_dot2c_f32_bf16_dpp v18, v34, v169 row_newbcast:14 row_mask:0xf bank_mask:0xf
    v_dot2c_f32_bf16_dpp v19, v34, v181 row_newbcast:14 row_mask:0xf bank_mask:0xf
    v_dot2c_f32_bf16_dpp v20, v34, v170 row_newbcast:14 row_mask:0xf bank_mask:0xf
    v_dot2c_f32_bf16_dpp v21, v34, v182 row_newbcast:14 row_mask:0xf bank_mask:0xf
    v_dot2c_f32_bf16_dpp v22, v34, v171 row_newbcast:14 row_mask:0xf bank_mask:0xf
    v_dot2c_f32_bf16_dpp v23, v34, v183 row_newbcast:14 row_mask:0xf bank_mask:0xf
    v_dot2c_f32_bf16_dpp v16, v34, v176 row_newbcast:15 row_mask:0xf bank_mask:0xf
    v_dot2c_f32_bf16_dpp v17, v34, v188 row_newbcast:15 row_mask:0xf bank_mask:0xf
    v_dot2c_f32_bf16_dpp v18, v34, v177 row_newbcast:15 row_mask:0xf bank_mask:0xf
    v_dot2c_f32_bf16_dpp v19, v34, v189 row_newbcast:15 row_mask:0xf bank_mask:0xf
    v_dot2c_f32_bf16_dpp v20, v34, v178 row_newbcast:15 row_mask:0xf bank_mask:0xf
    v_dot2c_f32_bf16_dpp v21, v34, v190 row_newbcast:15 row_mask:0xf bank_mask:0xf
    v_dot2c_f32_bf16_dpp v22, v34, v179 row_newbcast:15 row_mask:0xf bank_mask:0xf
    v_dot2c_f32_bf16_dpp v23, v34, v191 row_newbcast:15 row_mask:0xf bank_mask:0xf
    v_permlane32_swap_b32 v16, v20
    v_permlane32_swap_b32 v17, v21
    v_permlane32_swap_b32 v18, v22
    v_permlane32_swap_b32 v19, v23
    v_add_f32 v16, v16, v20
    v_add_f32 v17, v17, v21
    v_add_f32 v18, v18, v22
    v_add_f32 v19, v19, v23
    s_nop 0
    v_permlane16_swap_b32 v16, v18
    v_permlane16_swap_b32 v17, v19
    v_add_f32 v16, v16, v18
    v_add_f32 v17, v17, v19
    v_mov_b32 v18, v16
    v_mov_b32 v32, v16
    v_mov_b32 v19, v17
    v_mov_b32 v33, v17
    v_permlane16_swap_b32 v32, v18
    s_nop 0
    v_permlane16_swap_b32 v33, v19
    v_min_u32 v16, -2, v16
    v_min_u32 v17, -2, v17
    v_min_u32 v18, -2, v18
    v_min_u32 v19, -2, v19
    buffer_store_dwordx4 v[16:19], v4, s[16:19], 0 offen sc1
    s_cmp_ge_u32 s24, 18
    s_cbranch_scc1 L_fin
    s_lshl_b32 s20, s24, 6
    s_add_u32 s20, s20, s21
    s_add_u32 s4, s58, s20
    s_addc_u32 s5, s59, 0
    s_mov_b32 s6, 64
    s_mov_b32 s7, 0x20000
L_poll:
    s_waitcnt vmcnt(0)
    v_max3_u32 v32, v212, v213, v214
    v_max3_u32 v32, v32, v215, v216
    v_max3_u32 v32, v32, v217, v218
    v_max3_u32 v32, v32, v219, v220
    v_max3_u32 v32, v32, v221, v222
    v_max3_u32 v32, v32, v223, v224
    v_max3_u32 v32, v32, v225, v226
    v_max_u32 v32, v32, v227
    v_cmp_eq_u32 vcc, -1, v32
    s_cbranch_vccz L_polldone
    s_mov_b64 exec, vcc
    buffer_load_dwordx4 v[212:215], v244, s[12:15], s25 offen sc1
    buffer_load_dwordx4 v[216:219], v244, s[12:15], s33 offen sc1
    buffer_load_dwordx4 v[220:223], v244, s[12:15], s34 offen sc1
    buffer_load_dwordx4 v[224:227], v244, s[12:15], s35 offen sc1
    s_mov_b64 exec, -1
    s_branch L_poll
L_polldone:
    v_add_f32 v212, v212, v216
    v_add_f32 v220, v220, v224
    v_add_f32 v213, v213, v217
    v_add_f32 v221, v221, v225
    v_add_f32 v214, v214, v218
    v_add_f32 v222, v222, v226
    v_add_f32 v215, v215, v219
    v_add_f32 v223, v223, v227
    v_add_f32 v212, v212, v220
    v_add_f32 v213, v213, v221
    v_add_f32 v214, v214, v222
    v_add_f32 v215, v215, v223
    s_nop 0
    v_permlane32_swap_b32 v212, v214
    v_permlane32_swap_b32 v213, v215
    v_add_f32 v212, v212, v214
    v_add_f32 v213, v213, v215
    s_nop 1
    v_permlane16_swap_b32 v212, v213
    v_add_f32 v212, v212, v213
    s_nop 1
    v_add_f32_dpp v212, v212, v212 row_ror:8 row_mask:0xf bank_mask:0xf
    v_cvt_pk_bf16_f32 v212, v212, v212
    buffer_store_short v212, v245, s[4:7], 0 offen sc1
L_fin:
L_end:
    s_endpgm
.section .rodata,"a"
.p2align 6
.amdhsa_kernel gated_mix__mha_block_cached__mixer_channel_mlp__decode_kernel
  .amdhsa_next_free_vgpr 256
  .amdhsa_next_free_sgpr 102
  .amdhsa_accum_offset 256
  .amdhsa_group_segment_fixed_size 0
  .amdhsa_kernarg_size 112
  .amdhsa_user_sgpr_count 2
  .amdhsa_user_sgpr_kernarg_segment_ptr 1
  .amdhsa_system_sgpr_workgroup_id_x 1
.end_amdhsa_kernel
```
